```python
import torch

def _softmax(x, axis=-1):
    return torch.softmax(x, dim=axis)
def _gelu(x):
    return torch.nn.functional.gelu(x, approximate="tanh")
def _silu(x):
    return torch.nn.functional.silu(x)
def _sigmoid(x):
    return torch.sigmoid(x)
def _layernorm(x, axis=-1, eps=1e-5):
    m = x.mean(dim=axis, keepdim=True)
    v = x.var(dim=axis, keepdim=True, unbiased=False)
    return (x - m) / torch.sqrt(v + eps)
def _scatter_add(tgt, idx, src, axis=0):
    return tgt.clone().index_add_(axis, idx, src)
def _segment_sum(src, seg, n):
    out = torch.zeros((n,) + src.shape[1:], dtype=src.dtype)
    return out.index_add_(0, seg, src)
def _pad(x, pw):
    flat = tuple(v for pair in reversed(pw) for v in pair)
    return torch.nn.functional.pad(x, flat)

kernel_name = 'concat_heads__sliding_local_dilated__grouped_kv_mqa__prompt'

def setup_inputs():

    _w = (lambda a: (lambda t: t.to(torch.bfloat16) if t.is_floating_point() else t)(torch.as_tensor(a)))
    def _A_setup():
        B, S, D = 1, 2048, 576
        return {
            "x": _w((lambda *s: torch.randn(*s, dtype=torch.bfloat16) * 0.1)(B, S, D)),
            "wqkv": _w((lambda *s: torch.randn(*s, dtype=torch.bfloat16) * 0.8)(D, 3 * D)),
            "wo": _w((lambda *s: torch.randn(*s, dtype=torch.bfloat16) * 0.8)(D, D)),
        }
    _A_in = _A_setup()

    def _B_setup():
        B, S, D, H = 1, 2048, 576, 32
        Dh = D // H
        return {
            "x": _w((lambda *s: torch.randn(*s, dtype=torch.bfloat16) * 0.05)(B, S, D)),
            "wq": _w((lambda *s: torch.randn(*s, dtype=torch.bfloat16) * 3.2)(D, H * Dh)),
            "wk": _w((lambda *s: torch.randn(*s, dtype=torch.bfloat16) * 3.2)(D, Dh)),
            "wv": _w((lambda *s: torch.randn(*s, dtype=torch.bfloat16) * 1.6)(D, Dh)),
            "wo": _w((lambda *s: torch.randn(*s, dtype=torch.bfloat16) * 1.6)(H * Dh, D)),
        }
    _B_in = _B_setup()

    return {
        "A_x": _A_in["x"],
        "A_wqkv": _A_in["wqkv"],
        "A_wo": _A_in["wo"],
        "B_x": _B_in["x"],
        "B_wq": _B_in["wq"],
        "B_wk": _B_in["wk"],
        "B_wv": _B_in["wv"],
        "B_wo": _B_in["wo"],
    }

def reference(A_x, A_wqkv, A_wo, B_x, B_wq, B_wk, B_wv, B_wo):
    def _A_ref(x, wqkv, wo):
        B, S, D = x.shape
        H = 32; Dh = D // H
        W, dil = 8, 2
        qkv = (lambda x, *d: x.permute(*d))((x @ wqkv).reshape(B, S, 3, H, Dh), 2, 0, 3, 1, 4)
        q, k, v = qkv[0], qkv[1], qkv[2]
        scale = Dh ** -0.5
        pos = torch.arange(S)
        off = torch.arange(W) * dil
        idx = pos[:, None] - off[None, :]
        mask = idx >= 0
        idx_c = torch.where(mask, idx, 0).reshape(-1)
        kg = k[:, :, idx_c, :].reshape(B, H, S, W, Dh)
        vg = v[:, :, idx_c, :].reshape(B, H, S, W, Dh)
        logits = torch.einsum("bhsd,bhswd->bhsw", q, kg) * scale
        logits = torch.where(mask[None, None, :, :], logits, -1e9)
        attn = _softmax(logits, axis=-1)
        o = torch.einsum("bhsw,bhswd->bhsd", attn, vg)
        return (lambda x, *d: x.permute(*d))(o, 0, 2, 1, 3).reshape(B, S, D) @ wo

    def _B_ref(x, wq, wk, wv, wo):
        B, S, D = x.shape
        H = 32
        Dh = D // H
        q = (lambda x, *d: x.permute(*d))((x @ wq).reshape(B, S, H, Dh), 0, 2, 1, 3)
        k = x @ wk
        v = x @ wv
        scores = torch.einsum("bhqd,bkd->bhqk", q, k) * (Dh ** -0.5)
        p = _softmax(scores, axis=-1)
        o = torch.einsum("bhqk,bkd->bhqd", p, v)
        return (lambda x, *d: x.permute(*d))(o, 0, 2, 1, 3).reshape(B, S, H * Dh) @ wo

    a = _A_ref(A_x, A_wqkv, A_wo)
    b = _B_ref(B_x, B_wq, B_wk, B_wv, B_wo)
    return torch.concatenate([a, b], axis=-1)
```

```asm
; @launch kernel=main_kernel grid=(256,1,1) block=(768,1,1) lds=163840
.amdgcn_target "amdgcn-amd-amdhsa--gfx950"
.text
.globl main_kernel
.p2align 8
.type main_kernel,@function
main_kernel:
    s_cmp_ge_u32 s2, 256
    s_cbranch_scc1 attn_exit
    v_lshrrev_b32 v13, 6, v0
    s_load_dwordx2 s[52:53], s[0:1], 0
    s_load_dwordx2 s[54:55], s[0:1], 8
    s_load_dwordx2 s[56:57], s[0:1], 24
    s_load_dwordx2 s[58:59], s[0:1], 32
    s_load_dwordx2 s[60:61], s[0:1], 40
    s_load_dwordx2 s[62:63], s[0:1], 48
    s_load_dwordx2 s[4:5], s[0:1], 80
    s_and_b32 s6, s2, 7
    s_lshr_b32 s7, s2, 3
    s_and_b32 s3, s7, 7
    s_lshr_b32 s7, s7, 3
    v_readfirstlane_b32 s32, v13
    s_load_dwordx2 s[50:51], s[0:1], 72
    s_waitcnt lgkmcnt(0)
    s_cmp_gt_u32 s2, 31
    s_cbranch_scc1 p0_noclr
    s_cmp_lg_u32 s32, 9
    s_cbranch_scc1 p0_noclr
    s_add_u32 s40, s4, 11018240
    s_addc_u32 s41, s5, 0
    v_and_b32 v1, 63, v0
    v_lshlrev_b32 v1, 3, v1
    s_lshl_b32 s42, s2, 9
    v_add_u32 v1, s42, v1
    v_mov_b32 v2, 0
    v_mov_b32 v3, 0
    global_store_dwordx2 v1, v[2:3], s[40:41] sc1
    s_waitcnt vmcnt(0)
    v_mov_b32 v3, 1
    s_mov_b64 exec, 1
    global_atomic_add v2, v3, s[50:51] sc1
    s_mov_b64 exec, -1
p0_noclr:
    s_lshr_b32 s7, s2, 3
    s_and_b32 s3, s7, 3
    s_lshr_b32 s7, s7, 2
    s_lshr_b32 s40, s6, 1
    s_lshl_b32 s40, s40, 2
    s_add_u32 s40, s40, s3
    s_and_b32 s6, s6, 1
    s_sub_u32 s42, 5, s6
    s_lshl_b32 s36, s40, 7
    s_mov_b32 s39, 6
    s_lshl_b32 s50, s3, 1
    s_add_u32 s50, s50, s7
    s_cmp_ge_u32 s50, 9
    s_cselect_b32 s51, 9, 0
    s_sub_u32 s50, s50, s51
    s_cmp_ge_u32 s7, s42
    s_cbranch_scc1 proj_B
    s_mul_i32 s41, s6, 5
    s_add_u32 s41, s41, s7
    s_mov_b32 s60, 1
    s_mov_b32 s61, s40
    s_mov_b32 s62, s41
    s_mov_b32 s8, s52
    s_mov_b32 s9, s53
    s_mov_b32 s10, 2359296
    s_mov_b32 s11, 0x00020000
    s_mov_b32 s12, s54
    s_mov_b32 s13, s55
    s_mov_b32 s14, 1990656
    s_mov_b32 s15, 0x00020000
    s_movk_i32 s33, 3456
    s_mul_i32 s37, s41, 384
    v_and_b32 v1, 63, v0
    v_lshrrev_b32 v13, 6, v0
    s_nop 0
    v_readfirstlane_b32 s32, v13
    s_nop 3
    s_cmp_lt_u32 s32, 4
    s_cbranch_scc1 pa_compute
    s_cmp_lt_u32 s32, 8
    s_cbranch_scc1 pa_loader
    s_waitcnt vmcnt(0)
    s_barrier
    s_barrier
    s_barrier
    s_barrier
    s_barrier
    s_barrier
    s_barrier
    s_barrier
    s_barrier
    s_barrier
    s_branch p1_done
pa_loader:
    s_sub_u32 s51, s32, 4
    v_lshrrev_b32 v13, 3, v1
    v_lshrrev_b32 v14, 4, v1
    v_and_b32 v15, 7, v1
    s_lshl_b32 s40, s51, 5
    s_add_u32 s40, s40, s36
    s_movk_i32 s41, 1152
    v_add_u32 v16, 0, v14
    v_and_b32 v16, 7, v16
    v_xor_b32 v16, v16, v15
    v_lshlrev_b32 v16, 4, v16
    v_add_u32 v17, 0, v13
    v_add_u32 v17, s40, v17
    v_mul_lo_u32 v17, v17, s41
    v_add_u32 v2, v16, v17
    v_add_u32 v16, 4, v14
    v_and_b32 v16, 7, v16
    v_xor_b32 v16, v16, v15
    v_lshlrev_b32 v16, 4, v16
    v_add_u32 v17, 8, v13
    v_add_u32 v17, s40, v17
    v_mul_lo_u32 v17, v17, s41
    v_add_u32 v3, v16, v17
    v_add_u32 v16, 8, v14
    v_and_b32 v16, 7, v16
    v_xor_b32 v16, v16, v15
    v_lshlrev_b32 v16, 4, v16
    v_add_u32 v17, 16, v13
    v_add_u32 v17, s40, v17
    v_mul_lo_u32 v17, v17, s41
    v_add_u32 v4, v16, v17
    v_add_u32 v16, 12, v14
    v_and_b32 v16, 7, v16
    v_xor_b32 v16, v16, v15
    v_lshlrev_b32 v16, 4, v16
    v_add_u32 v17, 24, v13
    v_add_u32 v17, s40, v17
    v_mul_lo_u32 v17, v17, s41
    v_add_u32 v5, v16, v17
    v_lshrrev_b32 v16, 2, v1
    s_lshl_b32 s40, s51, 4
    v_add_u32 v16, s40, v16
    v_mul_lo_u32 v16, v16, s33
    v_and_b32 v17, 3, v1
    v_lshlrev_b32 v17, 4, v17
    v_add_u32 v16, v16, v17
    v_add_u32 v6, s37, v16
    s_lshl_b32 s48, s33, 6
    s_mov_b32 s46, s50
    s_lshl_b32 s44, s51, 12
    s_lshl_b32 s45, s51, 10
    s_add_u32 s45, s45, 16384
    s_lshl_b32 s41, s46, 7
    s_mul_i32 s42, s46, s48
    s_add_u32 s46, s46, 1
    s_cmp_eq_u32 s46, 9
    s_cselect_b32 s46, 0, s46
    s_add_u32 m0, s44, 0
    s_nop 0
    buffer_load_dwordx4 v2, s[8:11], s41 offen lds
    s_add_u32 m0, s44, 1024
    s_nop 0
    buffer_load_dwordx4 v3, s[8:11], s41 offen lds
    s_add_u32 m0, s44, 2048
    s_nop 0
    buffer_load_dwordx4 v4, s[8:11], s41 offen lds
    s_add_u32 m0, s44, 3072
    s_nop 0
    buffer_load_dwordx4 v5, s[8:11], s41 offen lds
    s_add_u32 m0, s45, 0
    s_nop 0
    buffer_load_dwordx4 v6, s[12:15], s42 offen offset:0 lds
    s_add_u32 m0, s45, 4032
    s_nop 0
    buffer_load_dwordx4 v6, s[12:15], s42 offen offset:64 lds
    s_add_u32 m0, s45, 8064
    s_nop 0
    buffer_load_dwordx4 v6, s[12:15], s42 offen offset:128 lds
    s_add_u32 m0, s45, 12096
    s_nop 0
    buffer_load_dwordx4 v6, s[12:15], s42 offen offset:192 lds
    s_add_u32 m0, s45, 16128
    s_nop 0
    buffer_load_dwordx4 v6, s[12:15], s42 offen offset:256 lds
    s_add_u32 m0, s45, 20160
    s_nop 0
    buffer_load_dwordx4 v6, s[12:15], s42 offen offset:320 lds
    s_lshl_b32 s41, s46, 7
    s_mul_i32 s42, s46, s48
    s_add_u32 s46, s46, 1
    s_cmp_eq_u32 s46, 9
    s_cselect_b32 s46, 0, s46
    s_add_u32 m0, s44, 40960
    s_nop 0
    buffer_load_dwordx4 v2, s[8:11], s41 offen lds
    s_add_u32 m0, s44, 41984
    s_nop 0
    buffer_load_dwordx4 v3, s[8:11], s41 offen lds
    s_add_u32 m0, s44, 43008
    s_nop 0
    buffer_load_dwordx4 v4, s[8:11], s41 offen lds
    s_add_u32 m0, s44, 44032
    s_nop 0
    buffer_load_dwordx4 v5, s[8:11], s41 offen lds
    s_add_u32 m0, s45, 40960
    s_nop 0
    buffer_load_dwordx4 v6, s[12:15], s42 offen offset:0 lds
    s_add_u32 m0, s45, 44992
    s_nop 0
    buffer_load_dwordx4 v6, s[12:15], s42 offen offset:64 lds
    s_add_u32 m0, s45, 49024
    s_nop 0
    buffer_load_dwordx4 v6, s[12:15], s42 offen offset:128 lds
    s_add_u32 m0, s45, 53056
    s_nop 0
    buffer_load_dwordx4 v6, s[12:15], s42 offen offset:192 lds
    s_add_u32 m0, s45, 57088
    s_nop 0
    buffer_load_dwordx4 v6, s[12:15], s42 offen offset:256 lds
    s_add_u32 m0, s45, 61120
    s_nop 0
    buffer_load_dwordx4 v6, s[12:15], s42 offen offset:320 lds
    s_waitcnt vmcnt(10)
    s_barrier
    s_lshl_b32 s41, s46, 7
    s_mul_i32 s42, s46, s48
    s_add_u32 s46, s46, 1
    s_cmp_eq_u32 s46, 9
    s_cselect_b32 s46, 0, s46
    s_add_u32 m0, s44, 81920
    s_nop 0
    buffer_load_dwordx4 v2, s[8:11], s41 offen lds
    s_add_u32 m0, s44, 82944
    s_nop 0
    buffer_load_dwordx4 v3, s[8:11], s41 offen lds
    s_add_u32 m0, s44, 83968
    s_nop 0
    buffer_load_dwordx4 v4, s[8:11], s41 offen lds
    s_add_u32 m0, s44, 84992
    s_nop 0
    buffer_load_dwordx4 v5, s[8:11], s41 offen lds
    s_add_u32 m0, s45, 81920
    s_nop 0
    buffer_load_dwordx4 v6, s[12:15], s42 offen offset:0 lds
    s_add_u32 m0, s45, 85952
    s_nop 0
    buffer_load_dwordx4 v6, s[12:15], s42 offen offset:64 lds
    s_add_u32 m0, s45, 89984
    s_nop 0
    buffer_load_dwordx4 v6, s[12:15], s42 offen offset:128 lds
    s_add_u32 m0, s45, 94016
    s_nop 0
    buffer_load_dwordx4 v6, s[12:15], s42 offen offset:192 lds
    s_add_u32 m0, s45, 98048
    s_nop 0
    buffer_load_dwordx4 v6, s[12:15], s42 offen offset:256 lds
    s_add_u32 m0, s45, 102080
    s_nop 0
    buffer_load_dwordx4 v6, s[12:15], s42 offen offset:320 lds
    s_waitcnt vmcnt(10)
    s_barrier
    s_lshl_b32 s41, s46, 7
    s_mul_i32 s42, s46, s48
    s_add_u32 s46, s46, 1
    s_cmp_eq_u32 s46, 9
    s_cselect_b32 s46, 0, s46
    s_add_u32 m0, s44, 122880
    s_nop 0
    buffer_load_dwordx4 v2, s[8:11], s41 offen lds
    s_add_u32 m0, s44, 123904
    s_nop 0
    buffer_load_dwordx4 v3, s[8:11], s41 offen lds
    s_add_u32 m0, s44, 124928
    s_nop 0
    buffer_load_dwordx4 v4, s[8:11], s41 offen lds
    s_add_u32 m0, s44, 125952
    s_nop 0
    buffer_load_dwordx4 v5, s[8:11], s41 offen lds
    s_add_u32 m0, s45, 122880
    s_nop 0
    buffer_load_dwordx4 v6, s[12:15], s42 offen offset:0 lds
    s_add_u32 m0, s45, 126912
    s_nop 0
    buffer_load_dwordx4 v6, s[12:15], s42 offen offset:64 lds
    s_add_u32 m0, s45, 130944
    s_nop 0
    buffer_load_dwordx4 v6, s[12:15], s42 offen offset:128 lds
    s_add_u32 m0, s45, 134976
    s_nop 0
    buffer_load_dwordx4 v6, s[12:15], s42 offen offset:192 lds
    s_add_u32 m0, s45, 139008
    s_nop 0
    buffer_load_dwordx4 v6, s[12:15], s42 offen offset:256 lds
    s_add_u32 m0, s45, 143040
    s_nop 0
    buffer_load_dwordx4 v6, s[12:15], s42 offen offset:320 lds
    s_waitcnt vmcnt(10)
    s_barrier
    s_lshl_b32 s41, s46, 7
    s_mul_i32 s42, s46, s48
    s_add_u32 s46, s46, 1
    s_cmp_eq_u32 s46, 9
    s_cselect_b32 s46, 0, s46
    s_add_u32 m0, s44, 0
    s_nop 0
    buffer_load_dwordx4 v2, s[8:11], s41 offen lds
    s_add_u32 m0, s44, 1024
    s_nop 0
    buffer_load_dwordx4 v3, s[8:11], s41 offen lds
    s_add_u32 m0, s44, 2048
    s_nop 0
    buffer_load_dwordx4 v4, s[8:11], s41 offen lds
    s_add_u32 m0, s44, 3072
    s_nop 0
    buffer_load_dwordx4 v5, s[8:11], s41 offen lds
    s_add_u32 m0, s45, 0
    s_nop 0
    buffer_load_dwordx4 v6, s[12:15], s42 offen offset:0 lds
    s_add_u32 m0, s45, 4032
    s_nop 0
    buffer_load_dwordx4 v6, s[12:15], s42 offen offset:64 lds
    s_add_u32 m0, s45, 8064
    s_nop 0
    buffer_load_dwordx4 v6, s[12:15], s42 offen offset:128 lds
    s_add_u32 m0, s45, 12096
    s_nop 0
    buffer_load_dwordx4 v6, s[12:15], s42 offen offset:192 lds
    s_add_u32 m0, s45, 16128
    s_nop 0
    buffer_load_dwordx4 v6, s[12:15], s42 offen offset:256 lds
    s_add_u32 m0, s45, 20160
    s_nop 0
    buffer_load_dwordx4 v6, s[12:15], s42 offen offset:320 lds
    s_waitcnt vmcnt(10)
    s_barrier
    s_lshl_b32 s41, s46, 7
    s_mul_i32 s42, s46, s48
    s_add_u32 s46, s46, 1
    s_cmp_eq_u32 s46, 9
    s_cselect_b32 s46, 0, s46
    s_add_u32 m0, s44, 40960
    s_nop 0
    buffer_load_dwordx4 v2, s[8:11], s41 offen lds
    s_add_u32 m0, s44, 41984
    s_nop 0
    buffer_load_dwordx4 v3, s[8:11], s41 offen lds
    s_add_u32 m0, s44, 43008
    s_nop 0
    buffer_load_dwordx4 v4, s[8:11], s41 offen lds
    s_add_u32 m0, s44, 44032
    s_nop 0
    buffer_load_dwordx4 v5, s[8:11], s41 offen lds
    s_add_u32 m0, s45, 40960
    s_nop 0
    buffer_load_dwordx4 v6, s[12:15], s42 offen offset:0 lds
    s_add_u32 m0, s45, 44992
    s_nop 0
    buffer_load_dwordx4 v6, s[12:15], s42 offen offset:64 lds
    s_add_u32 m0, s45, 49024
    s_nop 0
    buffer_load_dwordx4 v6, s[12:15], s42 offen offset:128 lds
    s_add_u32 m0, s45, 53056
    s_nop 0
    buffer_load_dwordx4 v6, s[12:15], s42 offen offset:192 lds
    s_add_u32 m0, s45, 57088
    s_nop 0
    buffer_load_dwordx4 v6, s[12:15], s42 offen offset:256 lds
    s_add_u32 m0, s45, 61120
    s_nop 0
    buffer_load_dwordx4 v6, s[12:15], s42 offen offset:320 lds
    s_waitcnt vmcnt(10)
    s_barrier
    s_lshl_b32 s41, s46, 7
    s_mul_i32 s42, s46, s48
    s_add_u32 s46, s46, 1
    s_cmp_eq_u32 s46, 9
    s_cselect_b32 s46, 0, s46
    s_add_u32 m0, s44, 81920
    s_nop 0
    buffer_load_dwordx4 v2, s[8:11], s41 offen lds
    s_add_u32 m0, s44, 82944
    s_nop 0
    buffer_load_dwordx4 v3, s[8:11], s41 offen lds
    s_add_u32 m0, s44, 83968
    s_nop 0
    buffer_load_dwordx4 v4, s[8:11], s41 offen lds
    s_add_u32 m0, s44, 84992
    s_nop 0
    buffer_load_dwordx4 v5, s[8:11], s41 offen lds
    s_add_u32 m0, s45, 81920
    s_nop 0
    buffer_load_dwordx4 v6, s[12:15], s42 offen offset:0 lds
    s_add_u32 m0, s45, 85952
    s_nop 0
    buffer_load_dwordx4 v6, s[12:15], s42 offen offset:64 lds
    s_add_u32 m0, s45, 89984
    s_nop 0
    buffer_load_dwordx4 v6, s[12:15], s42 offen offset:128 lds
    s_add_u32 m0, s45, 94016
    s_nop 0
    buffer_load_dwordx4 v6, s[12:15], s42 offen offset:192 lds
    s_add_u32 m0, s45, 98048
    s_nop 0
    buffer_load_dwordx4 v6, s[12:15], s42 offen offset:256 lds
    s_add_u32 m0, s45, 102080
    s_nop 0
    buffer_load_dwordx4 v6, s[12:15], s42 offen offset:320 lds
    s_waitcnt vmcnt(10)
    s_barrier
    s_lshl_b32 s41, s46, 7
    s_mul_i32 s42, s46, s48
    s_add_u32 s46, s46, 1
    s_cmp_eq_u32 s46, 9
    s_cselect_b32 s46, 0, s46
    s_add_u32 m0, s44, 122880
    s_nop 0
    buffer_load_dwordx4 v2, s[8:11], s41 offen lds
    s_add_u32 m0, s44, 123904
    s_nop 0
    buffer_load_dwordx4 v3, s[8:11], s41 offen lds
    s_add_u32 m0, s44, 124928
    s_nop 0
    buffer_load_dwordx4 v4, s[8:11], s41 offen lds
    s_add_u32 m0, s44, 125952
    s_nop 0
    buffer_load_dwordx4 v5, s[8:11], s41 offen lds
    s_add_u32 m0, s45, 122880
    s_nop 0
    buffer_load_dwordx4 v6, s[12:15], s42 offen offset:0 lds
    s_add_u32 m0, s45, 126912
    s_nop 0
    buffer_load_dwordx4 v6, s[12:15], s42 offen offset:64 lds
    s_add_u32 m0, s45, 130944
    s_nop 0
    buffer_load_dwordx4 v6, s[12:15], s42 offen offset:128 lds
    s_add_u32 m0, s45, 134976
    s_nop 0
    buffer_load_dwordx4 v6, s[12:15], s42 offen offset:192 lds
    s_add_u32 m0, s45, 139008
    s_nop 0
    buffer_load_dwordx4 v6, s[12:15], s42 offen offset:256 lds
    s_add_u32 m0, s45, 143040
    s_nop 0
    buffer_load_dwordx4 v6, s[12:15], s42 offen offset:320 lds
    s_waitcnt vmcnt(10)
    s_barrier
    s_lshl_b32 s41, s46, 7
    s_mul_i32 s42, s46, s48
    s_add_u32 s46, s46, 1
    s_cmp_eq_u32 s46, 9
    s_cselect_b32 s46, 0, s46
    s_add_u32 m0, s44, 0
    s_nop 0
    buffer_load_dwordx4 v2, s[8:11], s41 offen lds
    s_add_u32 m0, s44, 1024
    s_nop 0
    buffer_load_dwordx4 v3, s[8:11], s41 offen lds
    s_add_u32 m0, s44, 2048
    s_nop 0
    buffer_load_dwordx4 v4, s[8:11], s41 offen lds
    s_add_u32 m0, s44, 3072
    s_nop 0
    buffer_load_dwordx4 v5, s[8:11], s41 offen lds
    s_add_u32 m0, s45, 0
    s_nop 0
    buffer_load_dwordx4 v6, s[12:15], s42 offen offset:0 lds
    s_add_u32 m0, s45, 4032
    s_nop 0
    buffer_load_dwordx4 v6, s[12:15], s42 offen offset:64 lds
    s_add_u32 m0, s45, 8064
    s_nop 0
    buffer_load_dwordx4 v6, s[12:15], s42 offen offset:128 lds
    s_add_u32 m0, s45, 12096
    s_nop 0
    buffer_load_dwordx4 v6, s[12:15], s42 offen offset:192 lds
    s_add_u32 m0, s45, 16128
    s_nop 0
    buffer_load_dwordx4 v6, s[12:15], s42 offen offset:256 lds
    s_add_u32 m0, s45, 20160
    s_nop 0
    buffer_load_dwordx4 v6, s[12:15], s42 offen offset:320 lds
    s_waitcnt vmcnt(10)
    s_barrier
    s_waitcnt vmcnt(0)
    s_barrier
    s_waitcnt vmcnt(0)
    s_barrier
    s_branch p1_done
pa_compute:
    s_cmp_gt_u32 s2, 7
    s_cbranch_scc1 pg_nocw
    s_cmp_lg_u32 s32, 0
    s_cbranch_scc1 pg_nocw
    s_getpc_b64 s[56:57]
pg_cw_pc:
    s_add_u32 s56, s56, p1_done-pg_cw_pc
    s_addc_u32 s57, s57, 0
    v_lshlrev_b32 v13, 7, v1
    v_add_u32 v14, 0, v13
    v_min_u32 v14, code_end-p1_done-4, v14
    global_load_dword v2, v14, s[56:57]
    v_add_u32 v14, 8192, v13
    v_min_u32 v14, code_end-p1_done-4, v14
    global_load_dword v2, v14, s[56:57]
    v_add_u32 v14, 16384, v13
    v_min_u32 v14, code_end-p1_done-4, v14
    global_load_dword v2, v14, s[56:57]
    s_getpc_b64 s[56:57]
    s_add_u32 s56, s56, kd_start@rel32@lo+4
    s_addc_u32 s57, s57, kd_start@rel32@hi+12
    v_and_b32 v14, 3, v1
    v_lshlrev_b32 v14, 6, v14
    v_min_u32 v14, 128, v14
    global_load_dword v2, v14, s[56:57]
pg_nocw:
    v_bfe_u32 v13, v1, 2, 3
    s_mul_i32 s40, s6, 24
    s_add_u32 s40, s40, s36
    s_mul_i32 s41, s32, 6
    s_add_u32 s40, s40, s41
    v_add_u32 v14, s40, v13
    v_mul_u32_u24 v3, 1152, v14
    v_bfe_u32 v13, v1, 4, 2
    v_min_u32 v13, 3, v13
    s_mul_i32 s40, s3, 16
    s_mul_i32 s41, s32, 4
    s_add_u32 s40, s40, s41
    v_add_u32 v13, s40, v13
    v_mul_lo_u32 v13, v13, s33
    v_bfe_u32 v14, v1, 2, 2
    v_min_u32 v14, 1, v14
    v_lshlrev_b32 v14, 7, v14
    v_add_u32 v13, v13, v14
    v_add_u32 v4, s37, v13
    s_lshl_b32 s48, s33, 6
    s_movk_i32 s54, 256
    s_mul_i32 s55, s48, 2
    v_and_b32 v13, 31, v1
    v_lshrrev_b32 v14, 5, v1
    v_lshrrev_b32 v15, 1, v13
    v_and_b32 v15, 7, v15
    v_lshlrev_b32 v16, 7, v13
    s_lshl_b32 s40, s32, 12
    v_add_u32 v16, s40, v16
    v_lshlrev_b32 v17, 2, v14
    v_add_u32 v18, 0, v17
    v_xor_b32 v18, v18, v15
    v_lshlrev_b32 v18, 4, v18
    v_add_u32 v8, v16, v18
    v_add_u32 v18, 1, v17
    v_xor_b32 v18, v18, v15
    v_lshlrev_b32 v18, 4, v18
    v_add_u32 v9, v16, v18
    v_add_u32 v18, 2, v17
    v_xor_b32 v18, v18, v15
    v_lshlrev_b32 v18, 4, v18
    v_add_u32 v10, v16, v18
    v_add_u32 v18, 3, v17
    v_xor_b32 v18, v18, v15
    v_lshlrev_b32 v18, 4, v18
    v_add_u32 v11, v16, v18
    v_lshlrev_b32 v16, 11, v14
    v_bfe_u32 v17, v1, 2, 2
    v_lshlrev_b32 v17, 6, v17
    v_add_u32 v16, v16, v17
    v_bfe_u32 v17, v1, 4, 1
    v_lshlrev_b32 v17, 5, v17
    v_add_u32 v16, v16, v17
    v_and_b32 v17, 3, v1
    v_lshlrev_b32 v17, 3, v17
    v_add_u32 v16, v16, v17
    v_add_u32 v12, 16384, v16
    v_mov_b32 v72, 0
    v_mov_b32 v73, 0
    v_mov_b32 v74, 0
    v_mov_b32 v75, 0
    v_mov_b32 v76, 0
    v_mov_b32 v77, 0
    v_mov_b32 v78, 0
    v_mov_b32 v79, 0
    v_mov_b32 v80, 0
    v_mov_b32 v81, 0
    v_mov_b32 v82, 0
    v_mov_b32 v83, 0
    v_mov_b32 v84, 0
    v_mov_b32 v85, 0
    v_mov_b32 v86, 0
    v_mov_b32 v87, 0
    v_mov_b32 v88, 0
    v_mov_b32 v89, 0
    v_mov_b32 v90, 0
    v_mov_b32 v91, 0
    v_mov_b32 v92, 0
    v_mov_b32 v93, 0
    v_mov_b32 v94, 0
    v_mov_b32 v95, 0
    v_mov_b32 v96, 0
    v_mov_b32 v97, 0
    v_mov_b32 v98, 0
    v_mov_b32 v99, 0
    v_mov_b32 v100, 0
    v_mov_b32 v101, 0
    v_mov_b32 v102, 0
    v_mov_b32 v103, 0
    v_mov_b32 v104, 0
    v_mov_b32 v105, 0
    v_mov_b32 v106, 0
    v_mov_b32 v107, 0
    v_mov_b32 v108, 0
    v_mov_b32 v109, 0
    v_mov_b32 v110, 0
    v_mov_b32 v111, 0
    v_mov_b32 v112, 0
    v_mov_b32 v113, 0
    v_mov_b32 v114, 0
    v_mov_b32 v115, 0
    v_mov_b32 v116, 0
    v_mov_b32 v117, 0
    v_mov_b32 v118, 0
    v_mov_b32 v119, 0
    v_mov_b32 v120, 0
    v_mov_b32 v121, 0
    v_mov_b32 v122, 0
    v_mov_b32 v123, 0
    v_mov_b32 v124, 0
    v_mov_b32 v125, 0
    v_mov_b32 v126, 0
    v_mov_b32 v127, 0
    v_mov_b32 v128, 0
    v_mov_b32 v129, 0
    v_mov_b32 v130, 0
    v_mov_b32 v131, 0
    v_mov_b32 v132, 0
    v_mov_b32 v133, 0
    v_mov_b32 v134, 0
    v_mov_b32 v135, 0
    v_mov_b32 v136, 0
    v_mov_b32 v137, 0
    v_mov_b32 v138, 0
    v_mov_b32 v139, 0
    v_mov_b32 v140, 0
    v_mov_b32 v141, 0
    v_mov_b32 v142, 0
    v_mov_b32 v143, 0
    v_mov_b32 v144, 0
    v_mov_b32 v145, 0
    v_mov_b32 v146, 0
    v_mov_b32 v147, 0
    v_mov_b32 v148, 0
    v_mov_b32 v149, 0
    v_mov_b32 v150, 0
    v_mov_b32 v151, 0
    v_mov_b32 v152, 0
    v_mov_b32 v153, 0
    v_mov_b32 v154, 0
    v_mov_b32 v155, 0
    v_mov_b32 v156, 0
    v_mov_b32 v157, 0
    v_mov_b32 v158, 0
    v_mov_b32 v159, 0
    v_mov_b32 v160, 0
    v_mov_b32 v161, 0
    v_mov_b32 v162, 0
    v_mov_b32 v163, 0
    v_mov_b32 v164, 0
    v_mov_b32 v165, 0
    v_mov_b32 v166, 0
    v_mov_b32 v167, 0
    s_mov_b32 s7, 40960
    s_mov_b32 s40, 0
    s_mov_b32 s49, 0
    s_barrier
    ds_read_b128 v[16:19], v8
    ds_read_b64_tr_b16 v[20:21], v12 offset:0
    ds_read_b64_tr_b16 v[22:23], v12 offset:256
    ds_read_b64_tr_b16 v[24:25], v12 offset:4096
    ds_read_b64_tr_b16 v[26:27], v12 offset:4352
    ds_read_b64_tr_b16 v[28:29], v12 offset:8192
    ds_read_b64_tr_b16 v[30:31], v12 offset:8448
    ds_read_b64_tr_b16 v[32:33], v12 offset:12288
    ds_read_b64_tr_b16 v[34:35], v12 offset:12544
    ds_read_b64_tr_b16 v[36:37], v12 offset:16384
    ds_read_b64_tr_b16 v[38:39], v12 offset:16640
    ds_read_b64_tr_b16 v[40:41], v12 offset:20480
    ds_read_b64_tr_b16 v[42:43], v12 offset:20736
pa_loop:
    s_waitcnt lgkmcnt(10)
    v_mfma_f32_32x32x16_bf16 v[72:87], v[20:23], v[16:19], v[72:87]
    ds_read_b128 v[44:47], v9
    ds_read_b64_tr_b16 v[48:49], v12 offset:512
    ds_read_b64_tr_b16 v[50:51], v12 offset:768
    ds_read_b64_tr_b16 v[52:53], v12 offset:4608
    ds_read_b64_tr_b16 v[54:55], v12 offset:4864
    s_waitcnt lgkmcnt(13)
    v_mfma_f32_32x32x16_bf16 v[88:103], v[24:27], v[16:19], v[88:103]
    ds_read_b64_tr_b16 v[56:57], v12 offset:8704
    ds_read_b64_tr_b16 v[58:59], v12 offset:8960
    ds_read_b64_tr_b16 v[60:61], v12 offset:12800
    ds_read_b64_tr_b16 v[62:63], v12 offset:13056
    ds_read_b64_tr_b16 v[64:65], v12 offset:16896
    s_waitcnt lgkmcnt(15)
    v_mfma_f32_32x32x16_bf16 v[104:119], v[28:31], v[16:19], v[104:119]
    ds_read_b64_tr_b16 v[66:67], v12 offset:17152
    ds_read_b64_tr_b16 v[68:69], v12 offset:20992
    ds_read_b64_tr_b16 v[70:71], v12 offset:21248
    s_waitcnt lgkmcnt(15)
    v_mfma_f32_32x32x16_bf16 v[120:135], v[32:35], v[16:19], v[120:135]
    s_waitcnt lgkmcnt(15)
    v_mfma_f32_32x32x16_bf16 v[136:151], v[36:39], v[16:19], v[136:151]
    s_waitcnt lgkmcnt(13)
    v_mfma_f32_32x32x16_bf16 v[152:167], v[40:43], v[16:19], v[152:167]
    s_waitcnt lgkmcnt(10)
    v_mfma_f32_32x32x16_bf16 v[72:87], v[48:51], v[44:47], v[72:87]
    ds_read_b128 v[16:19], v10
    ds_read_b64_tr_b16 v[20:21], v12 offset:1024
    ds_read_b64_tr_b16 v[22:23], v12 offset:1280
    ds_read_b64_tr_b16 v[24:25], v12 offset:5120
    ds_read_b64_tr_b16 v[26:27], v12 offset:5376
    s_waitcnt lgkmcnt(13)
    v_mfma_f32_32x32x16_bf16 v[88:103], v[52:55], v[44:47], v[88:103]
    ds_read_b64_tr_b16 v[28:29], v12 offset:9216
    ds_read_b64_tr_b16 v[30:31], v12 offset:9472
    ds_read_b64_tr_b16 v[32:33], v12 offset:13312
    ds_read_b64_tr_b16 v[34:35], v12 offset:13568
    ds_read_b64_tr_b16 v[36:37], v12 offset:17408
    s_waitcnt lgkmcnt(15)
    v_mfma_f32_32x32x16_bf16 v[104:119], v[56:59], v[44:47], v[104:119]
    ds_read_b64_tr_b16 v[38:39], v12 offset:17664
    ds_read_b64_tr_b16 v[40:41], v12 offset:21504
    ds_read_b64_tr_b16 v[42:43], v12 offset:21760
    s_waitcnt lgkmcnt(15)
    v_mfma_f32_32x32x16_bf16 v[120:135], v[60:63], v[44:47], v[120:135]
    s_waitcnt lgkmcnt(15)
    v_mfma_f32_32x32x16_bf16 v[136:151], v[64:67], v[44:47], v[136:151]
    s_waitcnt lgkmcnt(13)
    v_mfma_f32_32x32x16_bf16 v[152:167], v[68:71], v[44:47], v[152:167]
    s_waitcnt lgkmcnt(10)
    v_mfma_f32_32x32x16_bf16 v[72:87], v[20:23], v[16:19], v[72:87]
    ds_read_b128 v[44:47], v11
    ds_read_b64_tr_b16 v[48:49], v12 offset:1536
    ds_read_b64_tr_b16 v[50:51], v12 offset:1792
    ds_read_b64_tr_b16 v[52:53], v12 offset:5632
    ds_read_b64_tr_b16 v[54:55], v12 offset:5888
    s_waitcnt lgkmcnt(13)
    v_mfma_f32_32x32x16_bf16 v[88:103], v[24:27], v[16:19], v[88:103]
    ds_read_b64_tr_b16 v[56:57], v12 offset:9728
    ds_read_b64_tr_b16 v[58:59], v12 offset:9984
    ds_read_b64_tr_b16 v[60:61], v12 offset:13824
    ds_read_b64_tr_b16 v[62:63], v12 offset:14080
    ds_read_b64_tr_b16 v[64:65], v12 offset:17920
    s_waitcnt lgkmcnt(15)
    v_mfma_f32_32x32x16_bf16 v[104:119], v[28:31], v[16:19], v[104:119]
    ds_read_b64_tr_b16 v[66:67], v12 offset:18176
    ds_read_b64_tr_b16 v[68:69], v12 offset:22016
    ds_read_b64_tr_b16 v[70:71], v12 offset:22272
    s_waitcnt lgkmcnt(15)
    v_mfma_f32_32x32x16_bf16 v[120:135], v[32:35], v[16:19], v[120:135]
    s_waitcnt lgkmcnt(15)
    v_mfma_f32_32x32x16_bf16 v[136:151], v[36:39], v[16:19], v[136:151]
    s_waitcnt lgkmcnt(13)
    v_mfma_f32_32x32x16_bf16 v[152:167], v[40:43], v[16:19], v[152:167]
    s_add_u32 s49, s49, 1
    s_cmp_eq_u32 s49, 4
    s_cselect_b32 s47, -122880, s7
    s_cselect_b32 s49, 0, s49
    v_add_u32 v8, s47, v8
    v_add_u32 v9, s47, v9
    v_add_u32 v10, s47, v10
    v_add_u32 v11, s47, v11
    v_add_u32 v12, s47, v12
    s_add_u32 s40, s40, 1
    s_cmp_lt_u32 s40, 9
    s_waitcnt lgkmcnt(0)
    v_mfma_f32_32x32x16_bf16 v[72:87], v[48:51], v[44:47], v[72:87]
    s_barrier
    ds_read_b128 v[16:19], v8
    ds_read_b64_tr_b16 v[20:21], v12 offset:0
    ds_read_b64_tr_b16 v[22:23], v12 offset:256
    ds_read_b64_tr_b16 v[24:25], v12 offset:4096
    ds_read_b64_tr_b16 v[26:27], v12 offset:4352
    v_mfma_f32_32x32x16_bf16 v[88:103], v[52:55], v[44:47], v[88:103]
    ds_read_b64_tr_b16 v[28:29], v12 offset:8192
    ds_read_b64_tr_b16 v[30:31], v12 offset:8448
    ds_read_b64_tr_b16 v[32:33], v12 offset:12288
    ds_read_b64_tr_b16 v[34:35], v12 offset:12544
    ds_read_b64_tr_b16 v[36:37], v12 offset:16384
    v_mfma_f32_32x32x16_bf16 v[104:119], v[56:59], v[44:47], v[104:119]
    ds_read_b64_tr_b16 v[38:39], v12 offset:16640
    ds_read_b64_tr_b16 v[40:41], v12 offset:20480
    ds_read_b64_tr_b16 v[42:43], v12 offset:20736
    v_mfma_f32_32x32x16_bf16 v[120:135], v[60:63], v[44:47], v[120:135]
    v_mfma_f32_32x32x16_bf16 v[136:151], v[64:67], v[44:47], v[136:151]
    v_mfma_f32_32x32x16_bf16 v[152:167], v[68:71], v[44:47], v[152:167]
    s_cbranch_scc1 pa_loop
    s_waitcnt vmcnt(0) lgkmcnt(0)
    s_nop 15
    s_nop 3
    v_and_b32 v13, 31, v1
    v_lshrrev_b32 v14, 5, v1
    v_lshlrev_b32 v15, 6, v13
    v_lshlrev_b32 v16, 3, v14
    v_add_u32 v15, v15, v16
    s_mul_i32 s40, s32, 12288
    s_add_u32 s40, s40, 106496
    v_add_u32 v15, s40, v15
    v_bfe_u32 v16, v13, 1, 2
    v_lshlrev_b32 v16, 4, v16
    v_xor_b32 v28, 0, v16
    v_add_u32 v28, v28, v15
    v_xor_b32 v29, 16, v16
    v_add_u32 v29, v29, v15
    v_xor_b32 v30, 32, v16
    v_add_u32 v30, v30, v15
    v_xor_b32 v31, 48, v16
    v_add_u32 v31, v31, v15
    v_cvt_pk_bf16_f32 v20, v72, v73
    v_cvt_pk_bf16_f32 v21, v74, v75
    v_cvt_pk_bf16_f32 v22, v76, v77
    v_cvt_pk_bf16_f32 v23, v78, v79
    v_cvt_pk_bf16_f32 v24, v80, v81
    v_cvt_pk_bf16_f32 v25, v82, v83
    v_cvt_pk_bf16_f32 v26, v84, v85
    v_cvt_pk_bf16_f32 v27, v86, v87
    ds_write_b64 v28, v[20:21] offset:0
    ds_write_b64 v29, v[22:23] offset:0
    ds_write_b64 v30, v[24:25] offset:0
    ds_write_b64 v31, v[26:27] offset:0
    v_cvt_pk_bf16_f32 v20, v88, v89
    v_cvt_pk_bf16_f32 v21, v90, v91
    v_cvt_pk_bf16_f32 v22, v92, v93
    v_cvt_pk_bf16_f32 v23, v94, v95
    v_cvt_pk_bf16_f32 v24, v96, v97
    v_cvt_pk_bf16_f32 v25, v98, v99
    v_cvt_pk_bf16_f32 v26, v100, v101
    v_cvt_pk_bf16_f32 v27, v102, v103
    ds_write_b64 v28, v[20:21] offset:2048
    ds_write_b64 v29, v[22:23] offset:2048
    ds_write_b64 v30, v[24:25] offset:2048
    ds_write_b64 v31, v[26:27] offset:2048
    v_cvt_pk_bf16_f32 v20, v104, v105
    v_cvt_pk_bf16_f32 v21, v106, v107
    v_cvt_pk_bf16_f32 v22, v108, v109
    v_cvt_pk_bf16_f32 v23, v110, v111
    v_cvt_pk_bf16_f32 v24, v112, v113
    v_cvt_pk_bf16_f32 v25, v114, v115
    v_cvt_pk_bf16_f32 v26, v116, v117
    v_cvt_pk_bf16_f32 v27, v118, v119
    ds_write_b64 v28, v[20:21] offset:4096
    ds_write_b64 v29, v[22:23] offset:4096
    ds_write_b64 v30, v[24:25] offset:4096
    ds_write_b64 v31, v[26:27] offset:4096
    v_cvt_pk_bf16_f32 v20, v120, v121
    v_cvt_pk_bf16_f32 v21, v122, v123
    v_cvt_pk_bf16_f32 v22, v124, v125
    v_cvt_pk_bf16_f32 v23, v126, v127
    v_cvt_pk_bf16_f32 v24, v128, v129
    v_cvt_pk_bf16_f32 v25, v130, v131
    v_cvt_pk_bf16_f32 v26, v132, v133
    v_cvt_pk_bf16_f32 v27, v134, v135
    ds_write_b64 v28, v[20:21] offset:6144
    ds_write_b64 v29, v[22:23] offset:6144
    ds_write_b64 v30, v[24:25] offset:6144
    ds_write_b64 v31, v[26:27] offset:6144
    v_cvt_pk_bf16_f32 v20, v136, v137
    v_cvt_pk_bf16_f32 v21, v138, v139
    v_cvt_pk_bf16_f32 v22, v140, v141
    v_cvt_pk_bf16_f32 v23, v142, v143
    v_cvt_pk_bf16_f32 v24, v144, v145
    v_cvt_pk_bf16_f32 v25, v146, v147
    v_cvt_pk_bf16_f32 v26, v148, v149
    v_cvt_pk_bf16_f32 v27, v150, v151
    ds_write_b64 v28, v[20:21] offset:8192
    ds_write_b64 v29, v[22:23] offset:8192
    ds_write_b64 v30, v[24:25] offset:8192
    ds_write_b64 v31, v[26:27] offset:8192
    v_cvt_pk_bf16_f32 v20, v152, v153
    v_cvt_pk_bf16_f32 v21, v154, v155
    v_cvt_pk_bf16_f32 v22, v156, v157
    v_cvt_pk_bf16_f32 v23, v158, v159
    v_cvt_pk_bf16_f32 v24, v160, v161
    v_cvt_pk_bf16_f32 v25, v162, v163
    v_cvt_pk_bf16_f32 v26, v164, v165
    v_cvt_pk_bf16_f32 v27, v166, v167
    ds_write_b64 v28, v[20:21] offset:10240
    ds_write_b64 v29, v[22:23] offset:10240
    ds_write_b64 v30, v[24:25] offset:10240
    ds_write_b64 v31, v[26:27] offset:10240
    s_waitcnt lgkmcnt(0)
    s_branch p1_done
proj_B:
    s_sub_u32 s41, s7, s42
    s_mul_i32 s43, s6, 3
    s_add_u32 s41, s41, s43
    s_mov_b32 s8, s56
    s_mov_b32 s9, s57
    s_mov_b32 s10, 2359296
    s_mov_b32 s11, 0x00020000
    s_mov_b32 s12, s58
    s_mov_b32 s13, s59
    s_mov_b32 s14, 663552
    s_mov_b32 s15, 0x00020000
    s_add_u32 s16, s4, 7340032
    s_addc_u32 s17, s5, 0
    s_mov_b32 s18, 2359296
    s_mov_b32 s19, 0x00020000
    s_movk_i32 s33, 1152
    s_movk_i32 s34, 1152
    s_mov_b32 s35, 0x3eae1a93
    s_mul_i32 s37, s41, 192
    s_mov_b32 s38, s37
    s_cmp_eq_u32 s41, 6
    s_cbranch_scc1 proj_special
    s_mov_b32 s60, 2
    s_mov_b32 s61, s40
    s_mov_b32 s62, s41
    v_and_b32 v1, 63, v0
    v_lshrrev_b32 v13, 6, v0
    s_nop 0
    v_readfirstlane_b32 s32, v13
    s_nop 3
    s_cmp_lt_u32 s32, 4
    s_cbranch_scc1 pg_compute
    s_cmp_lt_u32 s32, 8
    s_cbranch_scc1 pg_loader
    s_waitcnt vmcnt(0)
    s_barrier
    s_barrier
    s_barrier
    s_barrier
    s_barrier
    s_barrier
    s_barrier
    s_barrier
    s_barrier
    s_barrier
    s_branch p1_done
pg_loader:
    s_sub_u32 s51, s32, 4
    v_lshrrev_b32 v13, 3, v1
    v_lshrrev_b32 v14, 4, v1
    v_and_b32 v15, 7, v1
    s_lshl_b32 s40, s51, 5
    s_add_u32 s40, s40, s36
    s_movk_i32 s41, 1152
    v_add_u32 v16, 0, v14
    v_and_b32 v16, 7, v16
    v_xor_b32 v16, v16, v15
    v_lshlrev_b32 v16, 4, v16
    v_add_u32 v17, 0, v13
    v_add_u32 v17, s40, v17
    v_mul_lo_u32 v17, v17, s41
    v_add_u32 v2, v16, v17
    v_add_u32 v16, 4, v14
    v_and_b32 v16, 7, v16
    v_xor_b32 v16, v16, v15
    v_lshlrev_b32 v16, 4, v16
    v_add_u32 v17, 8, v13
    v_add_u32 v17, s40, v17
    v_mul_lo_u32 v17, v17, s41
    v_add_u32 v3, v16, v17
    v_add_u32 v16, 8, v14
    v_and_b32 v16, 7, v16
    v_xor_b32 v16, v16, v15
    v_lshlrev_b32 v16, 4, v16
    v_add_u32 v17, 16, v13
    v_add_u32 v17, s40, v17
    v_mul_lo_u32 v17, v17, s41
    v_add_u32 v4, v16, v17
    v_add_u32 v16, 12, v14
    v_and_b32 v16, 7, v16
    v_xor_b32 v16, v16, v15
    v_lshlrev_b32 v16, 4, v16
    v_add_u32 v17, 24, v13
    v_add_u32 v17, s40, v17
    v_mul_lo_u32 v17, v17, s41
    v_add_u32 v5, v16, v17
    v_lshrrev_b32 v16, 2, v1
    s_lshl_b32 s40, s51, 4
    v_add_u32 v16, s40, v16
    v_mul_lo_u32 v16, v16, s33
    v_and_b32 v17, 3, v1
    v_lshlrev_b32 v17, 4, v17
    v_add_u32 v16, v16, v17
    v_add_u32 v6, s37, v16
    s_lshl_b32 s48, s33, 6
    s_mov_b32 s46, s50
    s_lshl_b32 s44, s51, 12
    s_lshl_b32 s45, s51, 10
    s_add_u32 s45, s45, 16384
    s_lshl_b32 s41, s46, 7
    s_mul_i32 s42, s46, s48
    s_add_u32 s46, s46, 1
    s_cmp_eq_u32 s46, 9
    s_cselect_b32 s46, 0, s46
    s_add_u32 m0, s44, 0
    s_nop 0
    buffer_load_dwordx4 v2, s[8:11], s41 offen lds
    s_add_u32 m0, s44, 1024
    s_nop 0
    buffer_load_dwordx4 v3, s[8:11], s41 offen lds
    s_add_u32 m0, s44, 2048
    s_nop 0
    buffer_load_dwordx4 v4, s[8:11], s41 offen lds
    s_add_u32 m0, s44, 3072
    s_nop 0
    buffer_load_dwordx4 v5, s[8:11], s41 offen lds
    s_add_u32 m0, s45, 0
    s_nop 0
    buffer_load_dwordx4 v6, s[12:15], s42 offen offset:0 lds
    s_add_u32 m0, s45, 4032
    s_nop 0
    buffer_load_dwordx4 v6, s[12:15], s42 offen offset:64 lds
    s_add_u32 m0, s45, 8064
    s_nop 0
    buffer_load_dwordx4 v6, s[12:15], s42 offen offset:128 lds
    s_lshl_b32 s41, s46, 7
    s_mul_i32 s42, s46, s48
    s_add_u32 s46, s46, 1
    s_cmp_eq_u32 s46, 9
    s_cselect_b32 s46, 0, s46
    s_add_u32 m0, s44, 28672
    s_nop 0
    buffer_load_dwordx4 v2, s[8:11], s41 offen lds
    s_add_u32 m0, s44, 29696
    s_nop 0
    buffer_load_dwordx4 v3, s[8:11], s41 offen lds
    s_add_u32 m0, s44, 30720
    s_nop 0
    buffer_load_dwordx4 v4, s[8:11], s41 offen lds
    s_add_u32 m0, s44, 31744
    s_nop 0
    buffer_load_dwordx4 v5, s[8:11], s41 offen lds
    s_add_u32 m0, s45, 28672
    s_nop 0
    buffer_load_dwordx4 v6, s[12:15], s42 offen offset:0 lds
    s_add_u32 m0, s45, 32704
    s_nop 0
    buffer_load_dwordx4 v6, s[12:15], s42 offen offset:64 lds
    s_add_u32 m0, s45, 36736
    s_nop 0
    buffer_load_dwordx4 v6, s[12:15], s42 offen offset:128 lds
    s_waitcnt vmcnt(7)
    s_barrier
    s_lshl_b32 s41, s46, 7
    s_mul_i32 s42, s46, s48
    s_add_u32 s46, s46, 1
    s_cmp_eq_u32 s46, 9
    s_cselect_b32 s46, 0, s46
    s_add_u32 m0, s44, 57344
    s_nop 0
    buffer_load_dwordx4 v2, s[8:11], s41 offen lds
    s_add_u32 m0, s44, 58368
    s_nop 0
    buffer_load_dwordx4 v3, s[8:11], s41 offen lds
    s_add_u32 m0, s44, 59392
    s_nop 0
    buffer_load_dwordx4 v4, s[8:11], s41 offen lds
    s_add_u32 m0, s44, 60416
    s_nop 0
    buffer_load_dwordx4 v5, s[8:11], s41 offen lds
    s_add_u32 m0, s45, 57344
    s_nop 0
    buffer_load_dwordx4 v6, s[12:15], s42 offen offset:0 lds
    s_add_u32 m0, s45, 61376
    s_nop 0
    buffer_load_dwordx4 v6, s[12:15], s42 offen offset:64 lds
    s_add_u32 m0, s45, 65408
    s_nop 0
    buffer_load_dwordx4 v6, s[12:15], s42 offen offset:128 lds
    s_waitcnt vmcnt(7)
    s_barrier
    s_lshl_b32 s41, s46, 7
    s_mul_i32 s42, s46, s48
    s_add_u32 s46, s46, 1
    s_cmp_eq_u32 s46, 9
    s_cselect_b32 s46, 0, s46
    s_add_u32 m0, s44, 86016
    s_nop 0
    buffer_load_dwordx4 v2, s[8:11], s41 offen lds
    s_add_u32 m0, s44, 87040
    s_nop 0
    buffer_load_dwordx4 v3, s[8:11], s41 offen lds
    s_add_u32 m0, s44, 88064
    s_nop 0
    buffer_load_dwordx4 v4, s[8:11], s41 offen lds
    s_add_u32 m0, s44, 89088
    s_nop 0
    buffer_load_dwordx4 v5, s[8:11], s41 offen lds
    s_add_u32 m0, s45, 86016
    s_nop 0
    buffer_load_dwordx4 v6, s[12:15], s42 offen offset:0 lds
    s_add_u32 m0, s45, 90048
    s_nop 0
    buffer_load_dwordx4 v6, s[12:15], s42 offen offset:64 lds
    s_add_u32 m0, s45, 94080
    s_nop 0
    buffer_load_dwordx4 v6, s[12:15], s42 offen offset:128 lds
    s_waitcnt vmcnt(7)
    s_barrier
    s_lshl_b32 s41, s46, 7
    s_mul_i32 s42, s46, s48
    s_add_u32 s46, s46, 1
    s_cmp_eq_u32 s46, 9
    s_cselect_b32 s46, 0, s46
    s_add_u32 m0, s44, 114688
    s_nop 0
    buffer_load_dwordx4 v2, s[8:11], s41 offen lds
    s_add_u32 m0, s44, 115712
    s_nop 0
    buffer_load_dwordx4 v3, s[8:11], s41 offen lds
    s_add_u32 m0, s44, 116736
    s_nop 0
    buffer_load_dwordx4 v4, s[8:11], s41 offen lds
    s_add_u32 m0, s44, 117760
    s_nop 0
    buffer_load_dwordx4 v5, s[8:11], s41 offen lds
    s_add_u32 m0, s45, 114688
    s_nop 0
    buffer_load_dwordx4 v6, s[12:15], s42 offen offset:0 lds
    s_add_u32 m0, s45, 118720
    s_nop 0
    buffer_load_dwordx4 v6, s[12:15], s42 offen offset:64 lds
    s_add_u32 m0, s45, 122752
    s_nop 0
    buffer_load_dwordx4 v6, s[12:15], s42 offen offset:128 lds
    s_waitcnt vmcnt(7)
    s_barrier
    s_lshl_b32 s41, s46, 7
    s_mul_i32 s42, s46, s48
    s_add_u32 s46, s46, 1
    s_cmp_eq_u32 s46, 9
    s_cselect_b32 s46, 0, s46
    s_add_u32 m0, s44, 0
    s_nop 0
    buffer_load_dwordx4 v2, s[8:11], s41 offen lds
    s_add_u32 m0, s44, 1024
    s_nop 0
    buffer_load_dwordx4 v3, s[8:11], s41 offen lds
    s_add_u32 m0, s44, 2048
    s_nop 0
    buffer_load_dwordx4 v4, s[8:11], s41 offen lds
    s_add_u32 m0, s44, 3072
    s_nop 0
    buffer_load_dwordx4 v5, s[8:11], s41 offen lds
    s_add_u32 m0, s45, 0
    s_nop 0
    buffer_load_dwordx4 v6, s[12:15], s42 offen offset:0 lds
    s_add_u32 m0, s45, 4032
    s_nop 0
    buffer_load_dwordx4 v6, s[12:15], s42 offen offset:64 lds
    s_add_u32 m0, s45, 8064
    s_nop 0
    buffer_load_dwordx4 v6, s[12:15], s42 offen offset:128 lds
    s_waitcnt vmcnt(7)
    s_barrier
    s_lshl_b32 s41, s46, 7
    s_mul_i32 s42, s46, s48
    s_add_u32 s46, s46, 1
    s_cmp_eq_u32 s46, 9
    s_cselect_b32 s46, 0, s46
    s_add_u32 m0, s44, 28672
    s_nop 0
    buffer_load_dwordx4 v2, s[8:11], s41 offen lds
    s_add_u32 m0, s44, 29696
    s_nop 0
    buffer_load_dwordx4 v3, s[8:11], s41 offen lds
    s_add_u32 m0, s44, 30720
    s_nop 0
    buffer_load_dwordx4 v4, s[8:11], s41 offen lds
    s_add_u32 m0, s44, 31744
    s_nop 0
    buffer_load_dwordx4 v5, s[8:11], s41 offen lds
    s_add_u32 m0, s45, 28672
    s_nop 0
    buffer_load_dwordx4 v6, s[12:15], s42 offen offset:0 lds
    s_add_u32 m0, s45, 32704
    s_nop 0
    buffer_load_dwordx4 v6, s[12:15], s42 offen offset:64 lds
    s_add_u32 m0, s45, 36736
    s_nop 0
    buffer_load_dwordx4 v6, s[12:15], s42 offen offset:128 lds
    s_waitcnt vmcnt(7)
    s_barrier
    s_lshl_b32 s41, s46, 7
    s_mul_i32 s42, s46, s48
    s_add_u32 s46, s46, 1
    s_cmp_eq_u32 s46, 9
    s_cselect_b32 s46, 0, s46
    s_add_u32 m0, s44, 57344
    s_nop 0
    buffer_load_dwordx4 v2, s[8:11], s41 offen lds
    s_add_u32 m0, s44, 58368
    s_nop 0
    buffer_load_dwordx4 v3, s[8:11], s41 offen lds
    s_add_u32 m0, s44, 59392
    s_nop 0
    buffer_load_dwordx4 v4, s[8:11], s41 offen lds
    s_add_u32 m0, s44, 60416
    s_nop 0
    buffer_load_dwordx4 v5, s[8:11], s41 offen lds
    s_add_u32 m0, s45, 57344
    s_nop 0
    buffer_load_dwordx4 v6, s[12:15], s42 offen offset:0 lds
    s_add_u32 m0, s45, 61376
    s_nop 0
    buffer_load_dwordx4 v6, s[12:15], s42 offen offset:64 lds
    s_add_u32 m0, s45, 65408
    s_nop 0
    buffer_load_dwordx4 v6, s[12:15], s42 offen offset:128 lds
    s_waitcnt vmcnt(7)
    s_barrier
    s_lshl_b32 s41, s46, 7
    s_mul_i32 s42, s46, s48
    s_add_u32 s46, s46, 1
    s_cmp_eq_u32 s46, 9
    s_cselect_b32 s46, 0, s46
    s_add_u32 m0, s44, 86016
    s_nop 0
    buffer_load_dwordx4 v2, s[8:11], s41 offen lds
    s_add_u32 m0, s44, 87040
    s_nop 0
    buffer_load_dwordx4 v3, s[8:11], s41 offen lds
    s_add_u32 m0, s44, 88064
    s_nop 0
    buffer_load_dwordx4 v4, s[8:11], s41 offen lds
    s_add_u32 m0, s44, 89088
    s_nop 0
    buffer_load_dwordx4 v5, s[8:11], s41 offen lds
    s_add_u32 m0, s45, 86016
    s_nop 0
    buffer_load_dwordx4 v6, s[12:15], s42 offen offset:0 lds
    s_add_u32 m0, s45, 90048
    s_nop 0
    buffer_load_dwordx4 v6, s[12:15], s42 offen offset:64 lds
    s_add_u32 m0, s45, 94080
    s_nop 0
    buffer_load_dwordx4 v6, s[12:15], s42 offen offset:128 lds
    s_waitcnt vmcnt(7)
    s_barrier
    s_waitcnt vmcnt(0)
    s_barrier
    s_waitcnt vmcnt(0)
    s_barrier
    s_branch p1_done
pg_compute:
    v_bfe_u32 v13, v1, 2, 3
    s_mul_i32 s40, s6, 24
    s_add_u32 s40, s40, s36
    s_mul_i32 s41, s32, 6
    s_add_u32 s40, s40, s41
    v_add_u32 v14, s40, v13
    v_mul_u32_u24 v3, 1152, v14
    v_bfe_u32 v13, v1, 4, 2
    v_min_u32 v13, 3, v13
    s_mul_i32 s40, s3, 16
    s_mul_i32 s41, s32, 4
    s_add_u32 s40, s40, s41
    v_add_u32 v13, s40, v13
    v_mul_lo_u32 v13, v13, s33
    v_bfe_u32 v14, v1, 2, 2
    v_min_u32 v14, 1, v14
    v_lshlrev_b32 v14, 7, v14
    v_add_u32 v13, v13, v14
    v_add_u32 v4, s37, v13
    s_lshl_b32 s48, s33, 6
    s_movk_i32 s54, 256
    s_mul_i32 s55, s48, 2
    v_and_b32 v13, 31, v1
    v_lshrrev_b32 v14, 5, v1
    v_lshrrev_b32 v15, 1, v13
    v_and_b32 v15, 7, v15
    v_lshlrev_b32 v16, 7, v13
    s_lshl_b32 s40, s32, 12
    v_add_u32 v16, s40, v16
    v_lshlrev_b32 v17, 2, v14
    v_add_u32 v18, 0, v17
    v_xor_b32 v18, v18, v15
    v_lshlrev_b32 v18, 4, v18
    v_add_u32 v8, v16, v18
    v_add_u32 v18, 1, v17
    v_xor_b32 v18, v18, v15
    v_lshlrev_b32 v18, 4, v18
    v_add_u32 v9, v16, v18
    v_add_u32 v18, 2, v17
    v_xor_b32 v18, v18, v15
    v_lshlrev_b32 v18, 4, v18
    v_add_u32 v10, v16, v18
    v_add_u32 v18, 3, v17
    v_xor_b32 v18, v18, v15
    v_lshlrev_b32 v18, 4, v18
    v_add_u32 v11, v16, v18
    v_lshlrev_b32 v16, 11, v14
    v_bfe_u32 v17, v1, 2, 2
    v_lshlrev_b32 v17, 6, v17
    v_add_u32 v16, v16, v17
    v_bfe_u32 v17, v1, 4, 1
    v_lshlrev_b32 v17, 5, v17
    v_add_u32 v16, v16, v17
    v_and_b32 v17, 3, v1
    v_lshlrev_b32 v17, 3, v17
    v_add_u32 v16, v16, v17
    v_add_u32 v12, 16384, v16
    v_mov_b32 v64, 0
    v_mov_b32 v65, 0
    v_mov_b32 v66, 0
    v_mov_b32 v67, 0
    v_mov_b32 v68, 0
    v_mov_b32 v69, 0
    v_mov_b32 v70, 0
    v_mov_b32 v71, 0
    v_mov_b32 v72, 0
    v_mov_b32 v73, 0
    v_mov_b32 v74, 0
    v_mov_b32 v75, 0
    v_mov_b32 v76, 0
    v_mov_b32 v77, 0
    v_mov_b32 v78, 0
    v_mov_b32 v79, 0
    v_mov_b32 v80, 0
    v_mov_b32 v81, 0
    v_mov_b32 v82, 0
    v_mov_b32 v83, 0
    v_mov_b32 v84, 0
    v_mov_b32 v85, 0
    v_mov_b32 v86, 0
    v_mov_b32 v87, 0
    v_mov_b32 v88, 0
    v_mov_b32 v89, 0
    v_mov_b32 v90, 0
    v_mov_b32 v91, 0
    v_mov_b32 v92, 0
    v_mov_b32 v93, 0
    v_mov_b32 v94, 0
    v_mov_b32 v95, 0
    v_mov_b32 v96, 0
    v_mov_b32 v97, 0
    v_mov_b32 v98, 0
    v_mov_b32 v99, 0
    v_mov_b32 v100, 0
    v_mov_b32 v101, 0
    v_mov_b32 v102, 0
    v_mov_b32 v103, 0
    v_mov_b32 v104, 0
    v_mov_b32 v105, 0
    v_mov_b32 v106, 0
    v_mov_b32 v107, 0
    v_mov_b32 v108, 0
    v_mov_b32 v109, 0
    v_mov_b32 v110, 0
    v_mov_b32 v111, 0
    s_mov_b32 s7, 28672
    s_mov_b32 s40, 0
    s_mov_b32 s49, 0
    s_barrier
    ds_read_b128 v[16:19], v8
    ds_read_b64_tr_b16 v[20:21], v12 offset:0
    ds_read_b64_tr_b16 v[22:23], v12 offset:256
    ds_read_b64_tr_b16 v[24:25], v12 offset:4096
    ds_read_b64_tr_b16 v[26:27], v12 offset:4352
    ds_read_b64_tr_b16 v[28:29], v12 offset:8192
    ds_read_b64_tr_b16 v[30:31], v12 offset:8448
pg_loop:
    s_waitcnt lgkmcnt(4)
    v_mfma_f32_32x32x16_bf16 v[64:79], v[20:23], v[16:19], v[64:79]
    ds_read_b128 v[32:35], v9
    ds_read_b64_tr_b16 v[36:37], v12 offset:512
    ds_read_b64_tr_b16 v[38:39], v12 offset:768
    ds_read_b64_tr_b16 v[40:41], v12 offset:4608
    s_waitcnt lgkmcnt(6)
    v_mfma_f32_32x32x16_bf16 v[80:95], v[24:27], v[16:19], v[80:95]
    ds_read_b64_tr_b16 v[42:43], v12 offset:4864
    ds_read_b64_tr_b16 v[44:45], v12 offset:8704
    ds_read_b64_tr_b16 v[46:47], v12 offset:8960
    s_waitcnt lgkmcnt(7)
    v_mfma_f32_32x32x16_bf16 v[96:111], v[28:31], v[16:19], v[96:111]
    s_waitcnt lgkmcnt(4)
    v_mfma_f32_32x32x16_bf16 v[64:79], v[36:39], v[32:35], v[64:79]
    ds_read_b128 v[16:19], v10
    ds_read_b64_tr_b16 v[20:21], v12 offset:1024
    ds_read_b64_tr_b16 v[22:23], v12 offset:1280
    ds_read_b64_tr_b16 v[24:25], v12 offset:5120
    s_waitcnt lgkmcnt(6)
    v_mfma_f32_32x32x16_bf16 v[80:95], v[40:43], v[32:35], v[80:95]
    ds_read_b64_tr_b16 v[26:27], v12 offset:5376
    ds_read_b64_tr_b16 v[28:29], v12 offset:9216
    ds_read_b64_tr_b16 v[30:31], v12 offset:9472
    s_waitcnt lgkmcnt(7)
    v_mfma_f32_32x32x16_bf16 v[96:111], v[44:47], v[32:35], v[96:111]
    s_waitcnt lgkmcnt(4)
    v_mfma_f32_32x32x16_bf16 v[64:79], v[20:23], v[16:19], v[64:79]
    ds_read_b128 v[32:35], v11
    ds_read_b64_tr_b16 v[36:37], v12 offset:1536
    ds_read_b64_tr_b16 v[38:39], v12 offset:1792
    ds_read_b64_tr_b16 v[40:41], v12 offset:5632
    s_waitcnt lgkmcnt(6)
    v_mfma_f32_32x32x16_bf16 v[80:95], v[24:27], v[16:19], v[80:95]
    ds_read_b64_tr_b16 v[42:43], v12 offset:5888
    ds_read_b64_tr_b16 v[44:45], v12 offset:9728
    ds_read_b64_tr_b16 v[46:47], v12 offset:9984
    s_waitcnt lgkmcnt(7)
    v_mfma_f32_32x32x16_bf16 v[96:111], v[28:31], v[16:19], v[96:111]
    s_add_u32 s49, s49, 1
    s_cmp_eq_u32 s49, 5
    s_cselect_b32 s47, -114688, s7
    s_cselect_b32 s49, 0, s49
    v_add_u32 v8, s47, v8
    v_add_u32 v9, s47, v9
    v_add_u32 v10, s47, v10
    v_add_u32 v11, s47, v11
    v_add_u32 v12, s47, v12
    s_add_u32 s40, s40, 1
    s_cmp_lt_u32 s40, 9
    s_waitcnt lgkmcnt(0)
    v_mfma_f32_32x32x16_bf16 v[64:79], v[36:39], v[32:35], v[64:79]
    s_barrier
    ds_read_b128 v[16:19], v8
    ds_read_b64_tr_b16 v[20:21], v12 offset:0
    ds_read_b64_tr_b16 v[22:23], v12 offset:256
    ds_read_b64_tr_b16 v[24:25], v12 offset:4096
    ds_read_b64_tr_b16 v[26:27], v12 offset:4352
    ds_read_b64_tr_b16 v[28:29], v12 offset:8192
    ds_read_b64_tr_b16 v[30:31], v12 offset:8448
    v_mfma_f32_32x32x16_bf16 v[80:95], v[40:43], v[32:35], v[80:95]
    v_mfma_f32_32x32x16_bf16 v[96:111], v[44:47], v[32:35], v[96:111]
    s_cbranch_scc1 pg_loop
    s_waitcnt vmcnt(0) lgkmcnt(0)
    s_nop 15
    s_nop 3
    v_and_b32 v13, 31, v1
    v_lshrrev_b32 v14, 5, v1
    v_mul_u32_u24 v15, 80, v13
    v_lshlrev_b32 v16, 3, v14
    v_add_u32 v15, v15, v16
    s_mul_i32 s40, s32, 7680
    v_add_u32 v15, s40, v15
    v_lshrrev_b32 v16, 2, v1
    v_mul_u32_u24 v17, 80, v16
    v_and_b32 v18, 3, v1
    v_lshlrev_b32 v18, 4, v18
    v_add_u32 v17, v17, v18
    v_add_u32 v17, s40, v17
    s_lshl_b32 s41, s32, 5
    s_add_u32 s41, s41, s36
    v_add_u32 v16, s41, v16
    v_mul_lo_u32 v16, v16, s34
    v_add_u32 v16, v16, v18
    v_add_u32 v16, s38, v16
    s_lshl_b32 s42, s34, 4
    v_cvt_pk_bf16_f32 v20, v64, v65
    v_cvt_pk_bf16_f32 v21, v66, v67
    v_cvt_pk_bf16_f32 v22, v68, v69
    v_cvt_pk_bf16_f32 v23, v70, v71
    v_cvt_pk_bf16_f32 v24, v72, v73
    v_cvt_pk_bf16_f32 v25, v74, v75
    v_cvt_pk_bf16_f32 v26, v76, v77
    v_cvt_pk_bf16_f32 v27, v78, v79
    ds_write_b64 v15, v[20:21] offset:0
    ds_write_b64 v15, v[22:23] offset:16
    ds_write_b64 v15, v[24:25] offset:32
    ds_write_b64 v15, v[26:27] offset:48
    v_cvt_pk_bf16_f32 v20, v80, v81
    v_cvt_pk_bf16_f32 v21, v82, v83
    v_cvt_pk_bf16_f32 v22, v84, v85
    v_cvt_pk_bf16_f32 v23, v86, v87
    v_cvt_pk_bf16_f32 v24, v88, v89
    v_cvt_pk_bf16_f32 v25, v90, v91
    v_cvt_pk_bf16_f32 v26, v92, v93
    v_cvt_pk_bf16_f32 v27, v94, v95
    ds_write_b64 v15, v[20:21] offset:2560
    ds_write_b64 v15, v[22:23] offset:2576
    ds_write_b64 v15, v[24:25] offset:2592
    ds_write_b64 v15, v[26:27] offset:2608
    v_cvt_pk_bf16_f32 v20, v96, v97
    v_cvt_pk_bf16_f32 v21, v98, v99
    v_cvt_pk_bf16_f32 v22, v100, v101
    v_cvt_pk_bf16_f32 v23, v102, v103
    v_cvt_pk_bf16_f32 v24, v104, v105
    v_cvt_pk_bf16_f32 v25, v106, v107
    v_cvt_pk_bf16_f32 v26, v108, v109
    v_cvt_pk_bf16_f32 v27, v110, v111
    ds_write_b64 v15, v[20:21] offset:5120
    ds_write_b64 v15, v[22:23] offset:5136
    ds_write_b64 v15, v[24:25] offset:5152
    ds_write_b64 v15, v[26:27] offset:5168
    s_waitcnt lgkmcnt(0)
    ds_read_b128 v[20:23], v17 offset:0
    ds_read_b128 v[24:27], v17 offset:1280
    ds_read_b128 v[28:31], v17 offset:2560
    ds_read_b128 v[32:35], v17 offset:3840
    ds_read_b128 v[36:39], v17 offset:5120
    ds_read_b128 v[40:43], v17 offset:6400
    s_waitcnt lgkmcnt(4)
    buffer_store_dwordx4 v[20:23], v16, s[16:19], 0 offen offset:0 sc1
    buffer_store_dwordx4 v[24:27], v16, s[16:19], s42 offen offset:0 sc1
    s_waitcnt lgkmcnt(2)
    buffer_store_dwordx4 v[28:31], v16, s[16:19], 0 offen offset:64 sc1
    buffer_store_dwordx4 v[32:35], v16, s[16:19], s42 offen offset:64 sc1
    s_cmp_lt_u32 s39, 3
    s_cbranch_scc1 pg_skiplast
    s_waitcnt lgkmcnt(0)
    buffer_store_dwordx4 v[36:39], v16, s[16:19], 0 offen offset:128 sc1
    buffer_store_dwordx4 v[40:43], v16, s[16:19], s42 offen offset:128 sc1
pg_skiplast:
    s_branch p1_done
proj_special:
    s_mov_b32 s20, s60
    s_mov_b32 s21, s61
    s_mov_b32 s22, 20736
    s_mov_b32 s23, 0x00020000
    s_mov_b32 s24, s62
    s_mov_b32 s25, s63
    s_mov_b32 s26, 20736
    s_mov_b32 s27, 0x00020000
    s_mov_b32 s60, 3
    s_mov_b32 s61, s40
    s_cmp_lg_u32 s32, 0
    s_cbranch_scc1 ps_noclr
    s_add_u32 s28, s4, 11010048
    s_addc_u32 s29, s5, 0
    s_mov_b32 s30, 32768
    s_mov_b32 s31, 0x00020000
    v_and_b32 v1, 63, v0
    v_lshlrev_b32 v1, 2, v1
    v_mov_b32 v3, 0
    s_lshl_b32 s41, s40, 8
    buffer_store_dword v3, v1, s[28:31], s41 offen sc1
    s_add_u32 s41, s41, 4096
    buffer_store_dword v3, v1, s[28:31], s41 offen sc1
    s_add_u32 s41, s41, 20480
    buffer_store_dword v3, v1, s[28:31], s41 offen sc1
ps_noclr:
    s_add_u32 s28, s4, 10485760
    s_addc_u32 s29, s5, 0
    s_mov_b32 s30, 155648
    s_mov_b32 s31, 0x00020000
    v_and_b32 v1, 63, v0
    v_lshrrev_b32 v13, 6, v0
    s_nop 0
    v_readfirstlane_b32 s32, v13
    s_nop 3
    s_cmp_lt_u32 s32, 4
    s_cbranch_scc1 ps_compute
    s_cmp_lt_u32 s32, 8
    s_cbranch_scc1 ps_loader
    s_waitcnt vmcnt(0)
    s_barrier
    s_barrier
    s_barrier
    s_barrier
    s_barrier
    s_barrier
    s_barrier
    s_barrier
    s_barrier
    s_barrier
    s_branch p1_done
ps_loader:
    s_sub_u32 s51, s32, 4
    v_lshrrev_b32 v13, 3, v1
    v_lshrrev_b32 v14, 4, v1
    v_and_b32 v15, 7, v1
    s_lshl_b32 s40, s51, 5
    s_add_u32 s40, s40, s36
    s_movk_i32 s41, 1152
    v_add_u32 v16, 0, v14
    v_and_b32 v16, 7, v16
    v_xor_b32 v16, v16, v15
    v_lshlrev_b32 v16, 4, v16
    v_add_u32 v17, 0, v13
    v_add_u32 v17, s40, v17
    v_mul_lo_u32 v17, v17, s41
    v_add_u32 v2, v16, v17
    v_add_u32 v16, 4, v14
    v_and_b32 v16, 7, v16
    v_xor_b32 v16, v16, v15
    v_lshlrev_b32 v16, 4, v16
    v_add_u32 v17, 8, v13
    v_add_u32 v17, s40, v17
    v_mul_lo_u32 v17, v17, s41
    v_add_u32 v3, v16, v17
    v_add_u32 v16, 8, v14
    v_and_b32 v16, 7, v16
    v_xor_b32 v16, v16, v15
    v_lshlrev_b32 v16, 4, v16
    v_add_u32 v17, 16, v13
    v_add_u32 v17, s40, v17
    v_mul_lo_u32 v17, v17, s41
    v_add_u32 v4, v16, v17
    v_add_u32 v16, 12, v14
    v_and_b32 v16, 7, v16
    v_xor_b32 v16, v16, v15
    v_lshlrev_b32 v16, 4, v16
    v_add_u32 v17, 24, v13
    v_add_u32 v17, s40, v17
    v_mul_lo_u32 v17, v17, s41
    v_add_u32 v5, v16, v17
    v_lshrrev_b32 v16, 2, v1
    s_lshl_b32 s40, s51, 4
    v_add_u32 v16, s40, v16
    v_mul_lo_u32 v16, v16, s33
    v_and_b32 v17, 3, v1
    v_lshlrev_b32 v17, 4, v17
    v_add_u32 v16, v16, v17
    v_add_u32 v6, s37, v16
    v_add_u32 v16, s40, v14
    v_mul_u32_u24 v16, 36, v16
    v_and_b32 v17, 15, v1
    v_min_u32 v17, 8, v17
    v_lshlrev_b32 v17, 2, v17
    v_add_u32 v7, v16, v17
    s_lshl_b32 s48, s33, 6
    s_mov_b32 s46, s50
    s_lshl_b32 s44, s51, 12
    s_lshl_b32 s45, s51, 10
    s_add_u32 s45, s45, 16384
    s_lshl_b32 s41, s46, 7
    s_mul_i32 s42, s46, s48
    s_mul_i32 s43, s46, 2304
    s_add_u32 s46, s46, 1
    s_cmp_eq_u32 s46, 9
    s_cselect_b32 s46, 0, s46
    s_add_u32 m0, s44, 0
    s_nop 0
    buffer_load_dwordx4 v2, s[8:11], s41 offen lds
    s_add_u32 m0, s44, 1024
    s_nop 0
    buffer_load_dwordx4 v3, s[8:11], s41 offen lds
    s_add_u32 m0, s44, 2048
    s_nop 0
    buffer_load_dwordx4 v4, s[8:11], s41 offen lds
    s_add_u32 m0, s44, 3072
    s_nop 0
    buffer_load_dwordx4 v5, s[8:11], s41 offen lds
    s_add_u32 m0, s45, 0
    s_nop 0
    buffer_load_dword v7, s[20:23], s43 offen offset:0 lds
    s_add_u32 m0, s45, 112
    s_nop 0
    buffer_load_dword v7, s[20:23], s43 offen offset:144 lds
    s_add_u32 m0, s45, 224
    s_nop 0
    buffer_load_dword v7, s[20:23], s43 offen offset:288 lds
    s_add_u32 m0, s45, 336
    s_nop 0
    buffer_load_dword v7, s[20:23], s43 offen offset:432 lds
    s_add_u32 m0, s45, 4096
    s_nop 0
    buffer_load_dword v7, s[24:27], s43 offen offset:0 lds
    s_add_u32 m0, s45, 4208
    s_nop 0
    buffer_load_dword v7, s[24:27], s43 offen offset:144 lds
    s_add_u32 m0, s45, 4320
    s_nop 0
    buffer_load_dword v7, s[24:27], s43 offen offset:288 lds
    s_add_u32 m0, s45, 4432
    s_nop 0
    buffer_load_dword v7, s[24:27], s43 offen offset:432 lds
    s_lshl_b32 s41, s46, 7
    s_mul_i32 s42, s46, s48
    s_mul_i32 s43, s46, 2304
    s_add_u32 s46, s46, 1
    s_cmp_eq_u32 s46, 9
    s_cselect_b32 s46, 0, s46
    s_add_u32 m0, s44, 24576
    s_nop 0
    buffer_load_dwordx4 v2, s[8:11], s41 offen lds
    s_add_u32 m0, s44, 25600
    s_nop 0
    buffer_load_dwordx4 v3, s[8:11], s41 offen lds
    s_add_u32 m0, s44, 26624
    s_nop 0
    buffer_load_dwordx4 v4, s[8:11], s41 offen lds
    s_add_u32 m0, s44, 27648
    s_nop 0
    buffer_load_dwordx4 v5, s[8:11], s41 offen lds
    s_add_u32 m0, s45, 24576
    s_nop 0
    buffer_load_dword v7, s[20:23], s43 offen offset:0 lds
    s_add_u32 m0, s45, 24688
    s_nop 0
    buffer_load_dword v7, s[20:23], s43 offen offset:144 lds
    s_add_u32 m0, s45, 24800
    s_nop 0
    buffer_load_dword v7, s[20:23], s43 offen offset:288 lds
    s_add_u32 m0, s45, 24912
    s_nop 0
    buffer_load_dword v7, s[20:23], s43 offen offset:432 lds
    s_add_u32 m0, s45, 28672
    s_nop 0
    buffer_load_dword v7, s[24:27], s43 offen offset:0 lds
    s_add_u32 m0, s45, 28784
    s_nop 0
    buffer_load_dword v7, s[24:27], s43 offen offset:144 lds
    s_add_u32 m0, s45, 28896
    s_nop 0
    buffer_load_dword v7, s[24:27], s43 offen offset:288 lds
    s_add_u32 m0, s45, 29008
    s_nop 0
    buffer_load_dword v7, s[24:27], s43 offen offset:432 lds
    s_waitcnt vmcnt(12)
    s_barrier
    s_lshl_b32 s41, s46, 7
    s_mul_i32 s42, s46, s48
    s_mul_i32 s43, s46, 2304
    s_add_u32 s46, s46, 1
    s_cmp_eq_u32 s46, 9
    s_cselect_b32 s46, 0, s46
    s_add_u32 m0, s44, 49152
    s_nop 0
    buffer_load_dwordx4 v2, s[8:11], s41 offen lds
    s_add_u32 m0, s44, 50176
    s_nop 0
    buffer_load_dwordx4 v3, s[8:11], s41 offen lds
    s_add_u32 m0, s44, 51200
    s_nop 0
    buffer_load_dwordx4 v4, s[8:11], s41 offen lds
    s_add_u32 m0, s44, 52224
    s_nop 0
    buffer_load_dwordx4 v5, s[8:11], s41 offen lds
    s_add_u32 m0, s45, 49152
    s_nop 0
    buffer_load_dword v7, s[20:23], s43 offen offset:0 lds
    s_add_u32 m0, s45, 49264
    s_nop 0
    buffer_load_dword v7, s[20:23], s43 offen offset:144 lds
    s_add_u32 m0, s45, 49376
    s_nop 0
    buffer_load_dword v7, s[20:23], s43 offen offset:288 lds
    s_add_u32 m0, s45, 49488
    s_nop 0
    buffer_load_dword v7, s[20:23], s43 offen offset:432 lds
    s_add_u32 m0, s45, 53248
    s_nop 0
    buffer_load_dword v7, s[24:27], s43 offen offset:0 lds
    s_add_u32 m0, s45, 53360
    s_nop 0
    buffer_load_dword v7, s[24:27], s43 offen offset:144 lds
    s_add_u32 m0, s45, 53472
    s_nop 0
    buffer_load_dword v7, s[24:27], s43 offen offset:288 lds
    s_add_u32 m0, s45, 53584
    s_nop 0
    buffer_load_dword v7, s[24:27], s43 offen offset:432 lds
    s_waitcnt vmcnt(12)
    s_barrier
    s_lshl_b32 s41, s46, 7
    s_mul_i32 s42, s46, s48
    s_mul_i32 s43, s46, 2304
    s_add_u32 s46, s46, 1
    s_cmp_eq_u32 s46, 9
    s_cselect_b32 s46, 0, s46
    s_add_u32 m0, s44, 73728
    s_nop 0
    buffer_load_dwordx4 v2, s[8:11], s41 offen lds
    s_add_u32 m0, s44, 74752
    s_nop 0
    buffer_load_dwordx4 v3, s[8:11], s41 offen lds
    s_add_u32 m0, s44, 75776
    s_nop 0
    buffer_load_dwordx4 v4, s[8:11], s41 offen lds
    s_add_u32 m0, s44, 76800
    s_nop 0
    buffer_load_dwordx4 v5, s[8:11], s41 offen lds
    s_add_u32 m0, s45, 73728
    s_nop 0
    buffer_load_dword v7, s[20:23], s43 offen offset:0 lds
    s_add_u32 m0, s45, 73840
    s_nop 0
    buffer_load_dword v7, s[20:23], s43 offen offset:144 lds
    s_add_u32 m0, s45, 73952
    s_nop 0
    buffer_load_dword v7, s[20:23], s43 offen offset:288 lds
    s_add_u32 m0, s45, 74064
    s_nop 0
    buffer_load_dword v7, s[20:23], s43 offen offset:432 lds
    s_add_u32 m0, s45, 77824
    s_nop 0
    buffer_load_dword v7, s[24:27], s43 offen offset:0 lds
    s_add_u32 m0, s45, 77936
    s_nop 0
    buffer_load_dword v7, s[24:27], s43 offen offset:144 lds
    s_add_u32 m0, s45, 78048
    s_nop 0
    buffer_load_dword v7, s[24:27], s43 offen offset:288 lds
    s_add_u32 m0, s45, 78160
    s_nop 0
    buffer_load_dword v7, s[24:27], s43 offen offset:432 lds
    s_waitcnt vmcnt(12)
    s_barrier
    s_lshl_b32 s41, s46, 7
    s_mul_i32 s42, s46, s48
    s_mul_i32 s43, s46, 2304
    s_add_u32 s46, s46, 1
    s_cmp_eq_u32 s46, 9
    s_cselect_b32 s46, 0, s46
    s_add_u32 m0, s44, 98304
    s_nop 0
    buffer_load_dwordx4 v2, s[8:11], s41 offen lds
    s_add_u32 m0, s44, 99328
    s_nop 0
    buffer_load_dwordx4 v3, s[8:11], s41 offen lds
    s_add_u32 m0, s44, 100352
    s_nop 0
    buffer_load_dwordx4 v4, s[8:11], s41 offen lds
    s_add_u32 m0, s44, 101376
    s_nop 0
    buffer_load_dwordx4 v5, s[8:11], s41 offen lds
    s_add_u32 m0, s45, 98304
    s_nop 0
    buffer_load_dword v7, s[20:23], s43 offen offset:0 lds
    s_add_u32 m0, s45, 98416
    s_nop 0
    buffer_load_dword v7, s[20:23], s43 offen offset:144 lds
    s_add_u32 m0, s45, 98528
    s_nop 0
    buffer_load_dword v7, s[20:23], s43 offen offset:288 lds
    s_add_u32 m0, s45, 98640
    s_nop 0
    buffer_load_dword v7, s[20:23], s43 offen offset:432 lds
    s_add_u32 m0, s45, 102400
    s_nop 0
    buffer_load_dword v7, s[24:27], s43 offen offset:0 lds
    s_add_u32 m0, s45, 102512
    s_nop 0
    buffer_load_dword v7, s[24:27], s43 offen offset:144 lds
    s_add_u32 m0, s45, 102624
    s_nop 0
    buffer_load_dword v7, s[24:27], s43 offen offset:288 lds
    s_add_u32 m0, s45, 102736
    s_nop 0
    buffer_load_dword v7, s[24:27], s43 offen offset:432 lds
    s_waitcnt vmcnt(12)
    s_barrier
    s_lshl_b32 s41, s46, 7
    s_mul_i32 s42, s46, s48
    s_mul_i32 s43, s46, 2304
    s_add_u32 s46, s46, 1
    s_cmp_eq_u32 s46, 9
    s_cselect_b32 s46, 0, s46
    s_add_u32 m0, s44, 122880
    s_nop 0
    buffer_load_dwordx4 v2, s[8:11], s41 offen lds
    s_add_u32 m0, s44, 123904
    s_nop 0
    buffer_load_dwordx4 v3, s[8:11], s41 offen lds
    s_add_u32 m0, s44, 124928
    s_nop 0
    buffer_load_dwordx4 v4, s[8:11], s41 offen lds
    s_add_u32 m0, s44, 125952
    s_nop 0
    buffer_load_dwordx4 v5, s[8:11], s41 offen lds
    s_add_u32 m0, s45, 122880
    s_nop 0
    buffer_load_dword v7, s[20:23], s43 offen offset:0 lds
    s_add_u32 m0, s45, 122992
    s_nop 0
    buffer_load_dword v7, s[20:23], s43 offen offset:144 lds
    s_add_u32 m0, s45, 123104
    s_nop 0
    buffer_load_dword v7, s[20:23], s43 offen offset:288 lds
    s_add_u32 m0, s45, 123216
    s_nop 0
    buffer_load_dword v7, s[20:23], s43 offen offset:432 lds
    s_add_u32 m0, s45, 126976
    s_nop 0
    buffer_load_dword v7, s[24:27], s43 offen offset:0 lds
    s_add_u32 m0, s45, 127088
    s_nop 0
    buffer_load_dword v7, s[24:27], s43 offen offset:144 lds
    s_add_u32 m0, s45, 127200
    s_nop 0
    buffer_load_dword v7, s[24:27], s43 offen offset:288 lds
    s_add_u32 m0, s45, 127312
    s_nop 0
    buffer_load_dword v7, s[24:27], s43 offen offset:432 lds
    s_waitcnt vmcnt(12)
    s_barrier
    s_lshl_b32 s41, s46, 7
    s_mul_i32 s42, s46, s48
    s_mul_i32 s43, s46, 2304
    s_add_u32 s46, s46, 1
    s_cmp_eq_u32 s46, 9
    s_cselect_b32 s46, 0, s46
    s_add_u32 m0, s44, 0
    s_nop 0
    buffer_load_dwordx4 v2, s[8:11], s41 offen lds
    s_add_u32 m0, s44, 1024
    s_nop 0
    buffer_load_dwordx4 v3, s[8:11], s41 offen lds
    s_add_u32 m0, s44, 2048
    s_nop 0
    buffer_load_dwordx4 v4, s[8:11], s41 offen lds
    s_add_u32 m0, s44, 3072
    s_nop 0
    buffer_load_dwordx4 v5, s[8:11], s41 offen lds
    s_add_u32 m0, s45, 0
    s_nop 0
    buffer_load_dword v7, s[20:23], s43 offen offset:0 lds
    s_add_u32 m0, s45, 112
    s_nop 0
    buffer_load_dword v7, s[20:23], s43 offen offset:144 lds
    s_add_u32 m0, s45, 224
    s_nop 0
    buffer_load_dword v7, s[20:23], s43 offen offset:288 lds
    s_add_u32 m0, s45, 336
    s_nop 0
    buffer_load_dword v7, s[20:23], s43 offen offset:432 lds
    s_add_u32 m0, s45, 4096
    s_nop 0
    buffer_load_dword v7, s[24:27], s43 offen offset:0 lds
    s_add_u32 m0, s45, 4208
    s_nop 0
    buffer_load_dword v7, s[24:27], s43 offen offset:144 lds
    s_add_u32 m0, s45, 4320
    s_nop 0
    buffer_load_dword v7, s[24:27], s43 offen offset:288 lds
    s_add_u32 m0, s45, 4432
    s_nop 0
    buffer_load_dword v7, s[24:27], s43 offen offset:432 lds
    s_waitcnt vmcnt(12)
    s_barrier
    s_lshl_b32 s41, s46, 7
    s_mul_i32 s42, s46, s48
    s_mul_i32 s43, s46, 2304
    s_add_u32 s46, s46, 1
    s_cmp_eq_u32 s46, 9
    s_cselect_b32 s46, 0, s46
    s_add_u32 m0, s44, 24576
    s_nop 0
    buffer_load_dwordx4 v2, s[8:11], s41 offen lds
    s_add_u32 m0, s44, 25600
    s_nop 0
    buffer_load_dwordx4 v3, s[8:11], s41 offen lds
    s_add_u32 m0, s44, 26624
    s_nop 0
    buffer_load_dwordx4 v4, s[8:11], s41 offen lds
    s_add_u32 m0, s44, 27648
    s_nop 0
    buffer_load_dwordx4 v5, s[8:11], s41 offen lds
    s_add_u32 m0, s45, 24576
    s_nop 0
    buffer_load_dword v7, s[20:23], s43 offen offset:0 lds
    s_add_u32 m0, s45, 24688
    s_nop 0
    buffer_load_dword v7, s[20:23], s43 offen offset:144 lds
    s_add_u32 m0, s45, 24800
    s_nop 0
    buffer_load_dword v7, s[20:23], s43 offen offset:288 lds
    s_add_u32 m0, s45, 24912
    s_nop 0
    buffer_load_dword v7, s[20:23], s43 offen offset:432 lds
    s_add_u32 m0, s45, 28672
    s_nop 0
    buffer_load_dword v7, s[24:27], s43 offen offset:0 lds
    s_add_u32 m0, s45, 28784
    s_nop 0
    buffer_load_dword v7, s[24:27], s43 offen offset:144 lds
    s_add_u32 m0, s45, 28896
    s_nop 0
    buffer_load_dword v7, s[24:27], s43 offen offset:288 lds
    s_add_u32 m0, s45, 29008
    s_nop 0
    buffer_load_dword v7, s[24:27], s43 offen offset:432 lds
    s_waitcnt vmcnt(12)
    s_barrier
    s_lshl_b32 s41, s46, 7
    s_mul_i32 s42, s46, s48
    s_mul_i32 s43, s46, 2304
    s_add_u32 s46, s46, 1
    s_cmp_eq_u32 s46, 9
    s_cselect_b32 s46, 0, s46
    s_add_u32 m0, s44, 49152
    s_nop 0
    buffer_load_dwordx4 v2, s[8:11], s41 offen lds
    s_add_u32 m0, s44, 50176
    s_nop 0
    buffer_load_dwordx4 v3, s[8:11], s41 offen lds
    s_add_u32 m0, s44, 51200
    s_nop 0
    buffer_load_dwordx4 v4, s[8:11], s41 offen lds
    s_add_u32 m0, s44, 52224
    s_nop 0
    buffer_load_dwordx4 v5, s[8:11], s41 offen lds
    s_add_u32 m0, s45, 49152
    s_nop 0
    buffer_load_dword v7, s[20:23], s43 offen offset:0 lds
    s_add_u32 m0, s45, 49264
    s_nop 0
    buffer_load_dword v7, s[20:23], s43 offen offset:144 lds
    s_add_u32 m0, s45, 49376
    s_nop 0
    buffer_load_dword v7, s[20:23], s43 offen offset:288 lds
    s_add_u32 m0, s45, 49488
    s_nop 0
    buffer_load_dword v7, s[20:23], s43 offen offset:432 lds
    s_add_u32 m0, s45, 53248
    s_nop 0
    buffer_load_dword v7, s[24:27], s43 offen offset:0 lds
    s_add_u32 m0, s45, 53360
    s_nop 0
    buffer_load_dword v7, s[24:27], s43 offen offset:144 lds
    s_add_u32 m0, s45, 53472
    s_nop 0
    buffer_load_dword v7, s[24:27], s43 offen offset:288 lds
    s_add_u32 m0, s45, 53584
    s_nop 0
    buffer_load_dword v7, s[24:27], s43 offen offset:432 lds
    s_waitcnt vmcnt(12)
    s_barrier
    s_waitcnt vmcnt(0)
    s_barrier
    s_waitcnt vmcnt(0)
    s_barrier
    s_branch p1_done
ps_compute:
    v_bfe_u32 v13, v1, 2, 3
    s_mul_i32 s40, s6, 24
    s_add_u32 s40, s40, s36
    s_mul_i32 s41, s32, 6
    s_add_u32 s40, s40, s41
    v_add_u32 v14, s40, v13
    v_mul_u32_u24 v3, 1152, v14
    v_bfe_u32 v13, v1, 4, 2
    v_min_u32 v13, 3, v13
    s_mul_i32 s40, s3, 16
    s_mul_i32 s41, s32, 4
    s_add_u32 s40, s40, s41
    v_add_u32 v13, s40, v13
    v_mul_lo_u32 v13, v13, s33
    v_bfe_u32 v14, v1, 2, 2
    v_min_u32 v14, 1, v14
    v_lshlrev_b32 v14, 7, v14
    v_add_u32 v13, v13, v14
    v_add_u32 v4, s37, v13
    s_lshl_b32 s48, s33, 6
    s_movk_i32 s54, 256
    s_mul_i32 s55, s48, 2
    v_and_b32 v13, 31, v1
    v_lshrrev_b32 v14, 5, v1
    v_lshrrev_b32 v15, 1, v13
    v_and_b32 v15, 7, v15
    v_lshlrev_b32 v16, 7, v13
    s_lshl_b32 s40, s32, 12
    v_add_u32 v16, s40, v16
    v_lshlrev_b32 v17, 2, v14
    v_add_u32 v18, 0, v17
    v_xor_b32 v18, v18, v15
    v_lshlrev_b32 v18, 4, v18
    v_add_u32 v8, v16, v18
    v_add_u32 v18, 1, v17
    v_xor_b32 v18, v18, v15
    v_lshlrev_b32 v18, 4, v18
    v_add_u32 v9, v16, v18
    v_add_u32 v18, 2, v17
    v_xor_b32 v18, v18, v15
    v_lshlrev_b32 v18, 4, v18
    v_add_u32 v10, v16, v18
    v_add_u32 v18, 3, v17
    v_xor_b32 v18, v18, v15
    v_lshlrev_b32 v18, 4, v18
    v_add_u32 v11, v16, v18
    v_lshlrev_b32 v16, 11, v14
    v_bfe_u32 v17, v1, 2, 2
    v_lshlrev_b32 v17, 6, v17
    v_add_u32 v16, v16, v17
    v_bfe_u32 v17, v1, 4, 1
    v_lshlrev_b32 v17, 5, v17
    v_add_u32 v16, v16, v17
    v_and_b32 v17, 3, v1
    v_lshlrev_b32 v17, 3, v17
    v_add_u32 v16, v16, v17
    v_add_u32 v12, 16384, v16
    v_mov_b32 v64, 0
    v_mov_b32 v65, 0
    v_mov_b32 v66, 0
    v_mov_b32 v67, 0
    v_mov_b32 v68, 0
    v_mov_b32 v69, 0
    v_mov_b32 v70, 0
    v_mov_b32 v71, 0
    v_mov_b32 v72, 0
    v_mov_b32 v73, 0
    v_mov_b32 v74, 0
    v_mov_b32 v75, 0
    v_mov_b32 v76, 0
    v_mov_b32 v77, 0
    v_mov_b32 v78, 0
    v_mov_b32 v79, 0
    v_mov_b32 v80, 0
    v_mov_b32 v81, 0
    v_mov_b32 v82, 0
    v_mov_b32 v83, 0
    v_mov_b32 v84, 0
    v_mov_b32 v85, 0
    v_mov_b32 v86, 0
    v_mov_b32 v87, 0
    v_mov_b32 v88, 0
    v_mov_b32 v89, 0
    v_mov_b32 v90, 0
    v_mov_b32 v91, 0
    v_mov_b32 v92, 0
    v_mov_b32 v93, 0
    v_mov_b32 v94, 0
    v_mov_b32 v95, 0
    s_mov_b32 s7, 24576
    s_mov_b32 s40, 0
    s_mov_b32 s49, 0
    s_barrier
    ds_read_b128 v[16:19], v8
    ds_read_b64_tr_b16 v[20:21], v12 offset:0
    ds_read_b64_tr_b16 v[22:23], v12 offset:256
    ds_read_b64_tr_b16 v[24:25], v12 offset:4096
    ds_read_b64_tr_b16 v[26:27], v12 offset:4352
ps_loop:
    s_waitcnt lgkmcnt(2)
    v_mfma_f32_32x32x16_bf16 v[64:79], v[20:23], v[16:19], v[64:79]
    ds_read_b128 v[28:31], v9
    ds_read_b64_tr_b16 v[32:33], v12 offset:512
    ds_read_b64_tr_b16 v[34:35], v12 offset:768
    ds_read_b64_tr_b16 v[36:37], v12 offset:4608
    ds_read_b64_tr_b16 v[38:39], v12 offset:4864
    s_waitcnt lgkmcnt(5)
    v_mfma_f32_32x32x16_bf16 v[80:95], v[16:19], v[24:27], v[80:95]
    s_waitcnt lgkmcnt(2)
    v_mfma_f32_32x32x16_bf16 v[64:79], v[32:35], v[28:31], v[64:79]
    ds_read_b128 v[16:19], v10
    ds_read_b64_tr_b16 v[20:21], v12 offset:1024
    ds_read_b64_tr_b16 v[22:23], v12 offset:1280
    ds_read_b64_tr_b16 v[24:25], v12 offset:5120
    ds_read_b64_tr_b16 v[26:27], v12 offset:5376
    s_waitcnt lgkmcnt(5)
    v_mfma_f32_32x32x16_bf16 v[80:95], v[28:31], v[36:39], v[80:95]
    s_waitcnt lgkmcnt(2)
    v_mfma_f32_32x32x16_bf16 v[64:79], v[20:23], v[16:19], v[64:79]
    ds_read_b128 v[28:31], v11
    ds_read_b64_tr_b16 v[32:33], v12 offset:1536
    ds_read_b64_tr_b16 v[34:35], v12 offset:1792
    ds_read_b64_tr_b16 v[36:37], v12 offset:5632
    ds_read_b64_tr_b16 v[38:39], v12 offset:5888
    s_waitcnt lgkmcnt(5)
    v_mfma_f32_32x32x16_bf16 v[80:95], v[16:19], v[24:27], v[80:95]
    s_add_u32 s49, s49, 1
    s_cmp_eq_u32 s49, 6
    s_cselect_b32 s47, -122880, s7
    s_cselect_b32 s49, 0, s49
    v_add_u32 v8, s47, v8
    v_add_u32 v9, s47, v9
    v_add_u32 v10, s47, v10
    v_add_u32 v11, s47, v11
    v_add_u32 v12, s47, v12
    s_add_u32 s40, s40, 1
    s_cmp_lt_u32 s40, 9
    s_waitcnt lgkmcnt(0)
    v_mfma_f32_32x32x16_bf16 v[64:79], v[32:35], v[28:31], v[64:79]
    s_barrier
    ds_read_b128 v[16:19], v8
    ds_read_b64_tr_b16 v[20:21], v12 offset:0
    ds_read_b64_tr_b16 v[22:23], v12 offset:256
    ds_read_b64_tr_b16 v[24:25], v12 offset:4096
    ds_read_b64_tr_b16 v[26:27], v12 offset:4352
    v_mfma_f32_32x32x16_bf16 v[80:95], v[28:31], v[36:39], v[80:95]
    s_cbranch_scc1 ps_loop
    s_waitcnt vmcnt(0) lgkmcnt(0)
    s_nop 15
    s_nop 3
    v_and_b32 v13, 31, v1
    v_lshrrev_b32 v14, 5, v1
    v_mul_u32_u24 v15, 80, v13
    v_lshlrev_b32 v16, 3, v14
    v_add_u32 v15, v15, v16
    s_mul_i32 s40, s32, 5120
    v_add_u32 v15, s40, v15
    v_lshrrev_b32 v16, 2, v1
    v_mul_u32_u24 v17, 80, v16
    v_and_b32 v18, 3, v1
    v_lshlrev_b32 v18, 4, v18
    v_add_u32 v17, v17, v18
    v_add_u32 v17, s40, v17
    s_lshl_b32 s41, s32, 5
    s_add_u32 s41, s41, s36
    v_add_u32 v16, s41, v16
    v_mul_lo_u32 v16, v16, s34
    v_add_u32 v16, v16, v18
    v_add_u32 v16, s38, v16
    s_lshl_b32 s42, s34, 4
    s_waitcnt lgkmcnt(0)
    s_lshr_b32 s43, s41, 5
    s_mul_i32 s43, s43, 2432
    v_mul_f32 v64, s35, v64
    v_mul_f32 v65, s35, v65
    v_mul_f32 v66, s35, v66
    v_mul_f32 v67, s35, v67
    v_mul_f32 v68, s35, v68
    v_mul_f32 v69, s35, v69
    v_mul_f32 v70, s35, v70
    v_mul_f32 v71, s35, v71
    v_mul_f32 v72, s35, v72
    v_mul_f32 v73, s35, v73
    v_cvt_pk_bf16_f32 v48, v64, v65
    v_cvt_pk_bf16_f32 v49, v66, v67
    v_cvt_pk_bf16_f32 v50, v68, v69
    v_cvt_pk_bf16_f32 v51, v70, v71
    v_cvt_pk_bf16_f32 v52, v72, v73
    v_lshlrev_b32 v56, 4, v13
    v_lshlrev_b32 v57, 3, v14
    v_add_u32 v56, v56, v57
    buffer_store_dwordx2 v[48:49], v56, s[28:31], s43 offen sc1
    buffer_store_dwordx2 v[50:51], v56, s[28:31], s43 offen offset:512 sc1
    v_lshlrev_b32 v57, 2, v13
    v_cmp_gt_u32 vcc, 32, v1
    s_and_saveexec_b64 s[52:53], vcc
    buffer_store_dword v52, v57, s[28:31], s43 offen offset:1024 sc1
    s_mov_b64 exec, s[52:53]
    v_cvt_pk_bf16_f32 v40, v80, v81
    v_cvt_pk_bf16_f32 v41, v82, v83
    v_cvt_pk_bf16_f32 v42, v84, v85
    v_cvt_pk_bf16_f32 v43, v86, v87
    v_cvt_pk_bf16_f32 v44, v88, v89
    v_cvt_pk_bf16_f32 v45, v90, v91
    v_cvt_pk_bf16_f32 v46, v92, v93
    v_cvt_pk_bf16_f32 v47, v94, v95
    v_mov_b32 v58, 0x3f803f80
    v_cmp_eq_u32 vcc, 18, v13
    s_nop 1
    v_cndmask_b32 v40, v40, v58, vcc
    v_cndmask_b32 v41, v41, v58, vcc
    v_cndmask_b32 v42, v42, v58, vcc
    v_cndmask_b32 v43, v43, v58, vcc
    v_cndmask_b32 v44, v44, v58, vcc
    v_cndmask_b32 v45, v45, v58, vcc
    v_cndmask_b32 v46, v46, v58, vcc
    v_cndmask_b32 v47, v47, v58, vcc
    v_cmp_ne_u32 vcc, 19, v13
    s_nop 1
    v_cndmask_b32 v40, 0, v40, vcc
    v_cndmask_b32 v41, 0, v41, vcc
    v_cndmask_b32 v42, 0, v42, vcc
    v_cndmask_b32 v43, 0, v43, vcc
    v_cndmask_b32 v44, 0, v44, vcc
    v_cndmask_b32 v45, 0, v45, vcc
    v_cndmask_b32 v46, 0, v46, vcc
    v_cndmask_b32 v47, 0, v47, vcc
    v_lshlrev_b32 v56, 4, v13
    v_mul_u32_u24 v57, 320, v14
    v_add_u32 v56, v56, v57
    v_cmp_gt_u32 vcc, 20, v13
    s_and_saveexec_b64 s[52:53], vcc
    buffer_store_dwordx4 v[40:43], v56, s[28:31], s43 offen offset:1152 sc1
    buffer_store_dwordx4 v[44:47], v56, s[28:31], s43 offen offset:1792 sc1
    s_mov_b64 exec, s[52:53]
    s_branch p1_done
p1_done:
    s_load_dwordx2 s[50:51], s[0:1], 72
    s_cmp_lt_u32 s60, 2
    s_cbranch_scc1 p1_nodrain
    s_waitcnt vmcnt(0)
p1_nodrain:
    s_waitcnt lgkmcnt(0)
    s_cmp_lg_u32 s32, 8
    s_cbranch_scc1 p1_initok
    v_mov_b32 v4, 0
    s_mov_b32 s43, 0
p1_init:
    global_load_dword v7, v4, s[50:51] sc1
    s_waitcnt vmcnt(0)
    v_readfirstlane_b32 s35, v7
    s_add_u32 s43, s43, 1
    s_cmp_ge_u32 s35, 32
    s_cbranch_scc1 p1_initok
    s_sleep 8
    s_cmp_lt_u32 s43, 0x10000
    s_cbranch_scc1 p1_init
p1_initok:
    s_barrier
    s_cmp_lg_u32 s32, 8
    s_cbranch_scc1 p1_wait
    v_mov_b32 v5, 1
    v_and_b32 v1, 63, v0
    s_add_u32 s52, s4, 11018240
    s_addc_u32 s53, s5, 0
    s_cmp_lt_u32 s60, 2
    s_cbranch_scc1 p1_nosig
    s_mul_i32 s35, s61, 6
    s_add_u32 s35, s35, s62
    s_add_u32 s35, s35, 16
    s_cmp_eq_u32 s60, 3
    s_cselect_b32 s35, s61, s35
    s_lshl_b32 s35, s35, 2
    v_lshlrev_b32 v7, 9, v1
    v_add_u32 v4, s35, v7
    s_mov_b32 exec_hi, 0
    global_store_dword v4, v5, s[52:53] sc1
    s_mov_b64 exec, -1
p1_nosig:
    s_and_b32 s35, s2, 7
    s_lshl_b32 s35, s35, 1
    s_lshr_b32 s36, s2, 7
    s_add_u32 s35, s35, s36
    s_mul_i32 s35, s35, 6
    v_min_u32 v4, 21, v1
    v_add_u32 v6, s35, v4
    v_cmp_gt_u32 vcc, 16, v4
    s_lshr_b32 s36, s2, 3
    s_lshl_b32 s36, s36, 9
    v_cndmask_b32 v4, v6, v4, vcc
    v_lshlrev_b32 v4, 2, v4
    v_add_u32 v4, s36, v4
    s_mov_b32 s43, 0
p1_poll:
    global_load_dword v7, v4, s[52:53] sc1
    s_waitcnt vmcnt(0)
    v_cmp_ne_u32 vcc, 1, v7
    s_add_u32 s43, s43, 1
    s_cmp_eq_u64 vcc, 0
    s_cbranch_scc1 p1_ok
    s_sleep 4
    s_cmp_lt_u32 s43, 0x10000
    s_cbranch_scc1 p1_poll
p1_ok:
p1_wait:
    s_barrier
    s_load_dwordx2 s[4:5], s[0:1], 80
    s_load_dwordx2 s[46:47], s[0:1], 16
    s_load_dwordx2 s[48:49], s[0:1], 56
    s_load_dwordx4 s[28:31], s[0:1], 0
    v_and_b32 v1, 63, v0
    v_lshrrev_b32 v7, 6, v0
    v_and_b32 v2, 31, v1
    v_readfirstlane_b32 s32, v7
    v_lshrrev_b32 v3, 5, v1
    s_and_b32 s3, s2, 7
    s_lshl_b32 s33, s3, 8
    s_lshr_b32 s6, s2, 3
    s_lshl_b32 s35, s6, 3
    s_add_u32 s33, s33, s35
    v_lshlrev_b32 v7, 4, v1
    v_mul_u32_u24 v8, 36, v2
    v_lshlrev_b32 v9, 4, v3
    v_add_u32 v9, v8, v9
    s_waitcnt lgkmcnt(0)
    s_add_u32 s16, s4, 10485760
    s_addc_u32 s17, s5, 0
    s_mov_b32 s18, 155648
    s_mov_b32 s19, 0x00020000
    s_cmp_ge_u32 s32, 8
    s_cbranch_scc1 attn_helper
    s_add_u32 s33, s33, s32
    s_add_u32 s12, s4, 7340032
    s_addc_u32 s13, s5, 0
    s_mov_b32 s14, 2359296
    s_mov_b32 s15, 0x00020000
    s_mul_i32 s36, s33, 1152
    buffer_load_dwordx4 v[12:15], v9, s[12:15], s36 offen sc1
    buffer_load_dword v16, v8, s[12:15], s36 offen offset:32 sc1
    s_add_u32 s24, s4, 14680064
    s_addc_u32 s25, s5, 0
    s_mov_b32 s26, 2359296
    s_mov_b32 s27, 0x00020000
    v_lshlrev_b32 v4, 4, v1
    v_lshlrev_b32 v5, 2, v2
    v_add_u32 v5, 1024, v5
    v_min_u32 v6, 19, v2
    v_cmp_eq_u32 vcc, 22, v2
    v_mov_b32 v11, 18
    s_nop 0
    v_cndmask_b32 v6, v6, v11, vcc
    v_lshlrev_b32 v6, 4, v6
    v_mul_u32_u24 v11, 320, v3
    v_add_u32 v6, v6, v11
    v_add_u32 v6, 1152, v6
    v_cmp_gt_u32 vcc, 32, v1
    v_mov_b32 v17, 0
    v_mov_b32 v18, 0
    v_mov_b32 v19, 0
    s_mov_b32 s40, 0
    s_mov_b32 s50, 0x0047ffff
    s_mov_b32 s51, 0x0047ffff
    s_waitcnt vmcnt(0)
    s_barrier
    v_cndmask_b32 v16, 0, v16, vcc
    v_mov_b32 v10, 0xff800000
    ds_read_b128 v[100:103], v4 offset:0
    ds_read_b32 v104, v5 offset:0
    ds_read_b128 v[108:111], v4 offset:2432
    ds_read_b32 v112, v5 offset:2432
    ds_read_b128 v[116:119], v4 offset:4864
    ds_read_b32 v120, v5 offset:4864
    ds_read_b128 v[124:127], v4 offset:7296
    ds_read_b32 v128, v5 offset:7296
    v_mov_b32 v105, 0
    v_mov_b32 v113, 0
    v_mov_b32 v121, 0
    v_mov_b32 v129, 0
    s_waitcnt lgkmcnt(6)
    v_mfma_f32_32x32x16_bf16 v[36:51], v[100:103], v[12:15], 0
    s_waitcnt lgkmcnt(4)
    v_mfma_f32_32x32x16_bf16 v[52:67], v[108:111], v[12:15], 0
    s_waitcnt lgkmcnt(2)
    v_mfma_f32_32x32x16_bf16 v[68:83], v[116:119], v[12:15], 0
    s_waitcnt lgkmcnt(0)
    v_mfma_f32_32x32x16_bf16 v[84:99], v[124:127], v[12:15], 0
    s_nop 9
    v_mfma_f32_32x32x8_bf16 v[36:51], v[104:105], v[16:17], v[36:51]
    v_mfma_f32_32x32x8_bf16 v[52:67], v[112:113], v[16:17], v[52:67]
    v_mfma_f32_32x32x8_bf16 v[68:83], v[120:121], v[16:17], v[68:83]
    v_mfma_f32_32x32x8_bf16 v[84:99], v[128:129], v[16:17], v[84:99]
    s_nop 9
    v_max3_f32 v10, v36, v37, v10
    v_max3_f32 v10, v38, v39, v10
    v_max3_f32 v10, v40, v41, v10
    v_max3_f32 v10, v42, v43, v10
    v_max3_f32 v10, v44, v45, v10
    v_max3_f32 v10, v46, v47, v10
    v_max3_f32 v10, v48, v49, v10
    v_max3_f32 v10, v50, v51, v10
    v_max3_f32 v10, v52, v53, v10
    v_max3_f32 v10, v54, v55, v10
    v_max3_f32 v10, v56, v57, v10
    v_max3_f32 v10, v58, v59, v10
    v_max3_f32 v10, v60, v61, v10
    v_max3_f32 v10, v62, v63, v10
    v_max3_f32 v10, v64, v65, v10
    v_max3_f32 v10, v66, v67, v10
    v_max3_f32 v10, v68, v69, v10
    v_max3_f32 v10, v70, v71, v10
    v_max3_f32 v10, v72, v73, v10
    v_max3_f32 v10, v74, v75, v10
    v_max3_f32 v10, v76, v77, v10
    v_max3_f32 v10, v78, v79, v10
    v_max3_f32 v10, v80, v81, v10
    v_max3_f32 v10, v82, v83, v10
    s_nop 3
    v_max3_f32 v10, v84, v85, v10
    v_max3_f32 v10, v86, v87, v10
    v_max3_f32 v10, v88, v89, v10
    v_max3_f32 v10, v90, v91, v10
    v_max3_f32 v10, v92, v93, v10
    v_max3_f32 v10, v94, v95, v10
    v_max3_f32 v10, v96, v97, v10
    v_max3_f32 v10, v98, v99, v10
    v_mov_b32 v132, v4
    v_mov_b32 v133, v5
    v_mov_b32 v134, v6
    ds_read_b128 v[100:103], v132 offset:0
    ds_read_b32 v108, v133 offset:0
    ds_read_b128 v[104:107], v132 offset:2432
    ds_read_b32 v112, v133 offset:2432
    v_mov_b32 v11, v10
    s_nop 1
    v_permlane32_swap_b32 v10, v11
    v_max_f32 v10, v10, v11
    v_sub_f32 v10, 0, v10
    v_cvt_pk_bf16_f32 v20, v10, 0
    v_lshlrev_b32 v20, 16, v20
    v_sub_f32 v10, v10, v20
    v_cvt_pk_bf16_f32 v21, v10, 0
    v_lshlrev_b32 v21, 16, v21
    v_sub_f32 v10, v10, v21
    v_cmp_gt_u32 vcc, 32, v1
    v_cvt_pk_bf16_f32 v22, v20, v21
    v_cvt_pk_bf16_f32 v23, v10, 0
    v_cndmask_b32 v17, v23, v22, vcc
    v_mov_b32 v109, 0x3f803f80
    v_mov_b32 v113, 0x3f803f80
    s_waitcnt lgkmcnt(2)
    v_mfma_f32_32x32x16_bf16 v[36:51], v[100:103], v[12:15], 0
    v_mov_b32 v84, 0
    v_mov_b32 v85, 0
    v_mov_b32 v86, 0
    v_mov_b32 v87, 0
    v_mov_b32 v88, 0
    v_mov_b32 v89, 0
    v_mov_b32 v90, 0
    v_mov_b32 v91, 0
    v_mov_b32 v92, 0
    v_mov_b32 v93, 0
    v_mov_b32 v94, 0
    v_mov_b32 v95, 0
    v_mov_b32 v96, 0
    v_mov_b32 v97, 0
    v_mov_b32 v98, 0
    v_mov_b32 v99, 0
    v_mfma_f32_32x32x8_bf16 v[36:51], v[108:109], v[16:17], v[36:51]
    v_mov_b32 v76, 0
    v_mov_b32 v124, 0
    v_mov_b32 v77, 0
    v_mov_b32 v125, 0
    v_mov_b32 v78, 0
    v_mov_b32 v126, 0
    v_mov_b32 v79, 0
    v_mov_b32 v127, 0
    v_mov_b32 v80, 0
    v_mov_b32 v128, 0
    v_mov_b32 v81, 0
    v_mov_b32 v129, 0
    v_mov_b32 v82, 0
    v_mov_b32 v130, 0
    v_mov_b32 v83, 0
    v_mov_b32 v131, 0
    s_mov_b32 s42, 0
attn_loop1:
    s_waitcnt lgkmcnt(0)
    ds_read_b128 v[100:103], v132 offset:4864
    ds_read_b32 v108, v133 offset:4864
    ds_read_b128 v[116:119], v134 offset:0
    ds_read_b128 v[120:123], v134 offset:640
    v_mfma_f32_32x32x16_bf16 v[52:67], v[104:107], v[12:15], 0
    v_exp_f32 v36, v36
    v_exp_f32 v37, v37
    v_exp_f32 v38, v38
    v_exp_f32 v39, v39
    v_cvt_pk_bf16_f32 v68, v36, v37
    v_cvt_pk_bf16_f32 v69, v38, v39
    v_mfma_f32_32x32x16_bf16 v[84:99], v[124:127], v[76:79], v[84:99]
    v_exp_f32 v40, v40
    v_exp_f32 v41, v41
    v_exp_f32 v42, v42
    v_exp_f32 v43, v43
    v_cvt_pk_bf16_f32 v70, v40, v41
    v_cvt_pk_bf16_f32 v71, v42, v43
    v_mfma_f32_32x32x8_bf16 v[52:67], v[112:113], v[16:17], v[52:67]
    v_exp_f32 v44, v44
    v_exp_f32 v45, v45
    v_exp_f32 v46, v46
    v_exp_f32 v47, v47
    v_cvt_pk_bf16_f32 v72, v44, v45
    v_cvt_pk_bf16_f32 v73, v46, v47
    v_mfma_f32_32x32x16_bf16 v[84:99], v[128:131], v[80:83], v[84:99]
    v_exp_f32 v48, v48
    v_exp_f32 v49, v49
    v_exp_f32 v50, v50
    v_exp_f32 v51, v51
    v_cvt_pk_bf16_f32 v74, v48, v49
    v_cvt_pk_bf16_f32 v75, v50, v51
    s_waitcnt lgkmcnt(0)
    ds_read_b128 v[104:107], v132 offset:7296
    ds_read_b32 v112, v133 offset:7296
    ds_read_b128 v[124:127], v134 offset:2432
    ds_read_b128 v[128:131], v134 offset:3072
    v_mfma_f32_32x32x16_bf16 v[36:51], v[100:103], v[12:15], 0
    v_exp_f32 v52, v52
    v_exp_f32 v53, v53
    v_exp_f32 v54, v54
    v_exp_f32 v55, v55
    v_cvt_pk_bf16_f32 v76, v52, v53
    v_cvt_pk_bf16_f32 v77, v54, v55
    v_mfma_f32_32x32x16_bf16 v[84:99], v[116:119], v[68:71], v[84:99]
    v_exp_f32 v56, v56
    v_exp_f32 v57, v57
    v_exp_f32 v58, v58
    v_exp_f32 v59, v59
    v_cvt_pk_bf16_f32 v78, v56, v57
    v_cvt_pk_bf16_f32 v79, v58, v59
    v_mfma_f32_32x32x8_bf16 v[36:51], v[108:109], v[16:17], v[36:51]
    v_exp_f32 v60, v60
    v_exp_f32 v61, v61
    v_exp_f32 v62, v62
    v_exp_f32 v63, v63
    v_cvt_pk_bf16_f32 v80, v60, v61
    v_cvt_pk_bf16_f32 v81, v62, v63
    v_mfma_f32_32x32x16_bf16 v[84:99], v[120:123], v[72:75], v[84:99]
    v_exp_f32 v64, v64
    v_exp_f32 v65, v65
    v_exp_f32 v66, v66
    v_exp_f32 v67, v67
    v_cvt_pk_bf16_f32 v82, v64, v65
    v_cvt_pk_bf16_f32 v83, v66, v67
    s_waitcnt lgkmcnt(0)
    ds_read_b128 v[100:103], v132 offset:9728
    ds_read_b32 v108, v133 offset:9728
    ds_read_b128 v[116:119], v134 offset:4864
    ds_read_b128 v[120:123], v134 offset:5504
    v_mfma_f32_32x32x16_bf16 v[52:67], v[104:107], v[12:15], 0
    v_exp_f32 v36, v36
    v_exp_f32 v37, v37
    v_exp_f32 v38, v38
    v_exp_f32 v39, v39
    v_cvt_pk_bf16_f32 v68, v36, v37
    v_cvt_pk_bf16_f32 v69, v38, v39
    v_mfma_f32_32x32x16_bf16 v[84:99], v[124:127], v[76:79], v[84:99]
    v_exp_f32 v40, v40
    v_exp_f32 v41, v41
    v_exp_f32 v42, v42
    v_exp_f32 v43, v43
    v_cvt_pk_bf16_f32 v70, v40, v41
    v_cvt_pk_bf16_f32 v71, v42, v43
    v_mfma_f32_32x32x8_bf16 v[52:67], v[112:113], v[16:17], v[52:67]
    v_exp_f32 v44, v44
    v_exp_f32 v45, v45
    v_exp_f32 v46, v46
    v_exp_f32 v47, v47
    v_cvt_pk_bf16_f32 v72, v44, v45
    v_cvt_pk_bf16_f32 v73, v46, v47
    v_mfma_f32_32x32x16_bf16 v[84:99], v[128:131], v[80:83], v[84:99]
    v_exp_f32 v48, v48
    v_exp_f32 v49, v49
    v_exp_f32 v50, v50
    v_exp_f32 v51, v51
    v_cvt_pk_bf16_f32 v74, v48, v49
    v_cvt_pk_bf16_f32 v75, v50, v51
    s_waitcnt lgkmcnt(0)
    ds_read_b128 v[104:107], v132 offset:12160
    ds_read_b32 v112, v133 offset:12160
    ds_read_b128 v[124:127], v134 offset:7296
    ds_read_b128 v[128:131], v134 offset:7936
    v_mfma_f32_32x32x16_bf16 v[36:51], v[100:103], v[12:15], 0
    v_exp_f32 v52, v52
    v_exp_f32 v53, v53
    v_exp_f32 v54, v54
    v_exp_f32 v55, v55
    v_cvt_pk_bf16_f32 v76, v52, v53
    v_cvt_pk_bf16_f32 v77, v54, v55
    v_mfma_f32_32x32x16_bf16 v[84:99], v[116:119], v[68:71], v[84:99]
    v_exp_f32 v56, v56
    v_exp_f32 v57, v57
    v_exp_f32 v58, v58
    v_exp_f32 v59, v59
    v_cvt_pk_bf16_f32 v78, v56, v57
    v_cvt_pk_bf16_f32 v79, v58, v59
    v_mfma_f32_32x32x8_bf16 v[36:51], v[108:109], v[16:17], v[36:51]
    v_exp_f32 v60, v60
    v_exp_f32 v61, v61
    v_exp_f32 v62, v62
    v_exp_f32 v63, v63
    v_cvt_pk_bf16_f32 v80, v60, v61
    v_cvt_pk_bf16_f32 v81, v62, v63
    v_mfma_f32_32x32x16_bf16 v[84:99], v[120:123], v[72:75], v[84:99]
    v_exp_f32 v64, v64
    v_exp_f32 v65, v65
    v_exp_f32 v66, v66
    v_exp_f32 v67, v67
    v_cvt_pk_bf16_f32 v82, v64, v65
    v_cvt_pk_bf16_f32 v83, v66, v67
    s_waitcnt lgkmcnt(0)
    ds_read_b128 v[100:103], v132 offset:14592
    ds_read_b32 v108, v133 offset:14592
    ds_read_b128 v[116:119], v134 offset:9728
    ds_read_b128 v[120:123], v134 offset:10368
    v_mfma_f32_32x32x16_bf16 v[52:67], v[104:107], v[12:15], 0
    v_exp_f32 v36, v36
    v_exp_f32 v37, v37
    v_exp_f32 v38, v38
    v_exp_f32 v39, v39
    v_cvt_pk_bf16_f32 v68, v36, v37
    v_cvt_pk_bf16_f32 v69, v38, v39
    v_mfma_f32_32x32x16_bf16 v[84:99], v[124:127], v[76:79], v[84:99]
    v_exp_f32 v40, v40
    v_exp_f32 v41, v41
    v_exp_f32 v42, v42
    v_exp_f32 v43, v43
    v_cvt_pk_bf16_f32 v70, v40, v41
    v_cvt_pk_bf16_f32 v71, v42, v43
    v_mfma_f32_32x32x8_bf16 v[52:67], v[112:113], v[16:17], v[52:67]
    v_exp_f32 v44, v44
    v_exp_f32 v45, v45
    v_exp_f32 v46, v46
    v_exp_f32 v47, v47
    v_cvt_pk_bf16_f32 v72, v44, v45
    v_cvt_pk_bf16_f32 v73, v46, v47
    v_mfma_f32_32x32x16_bf16 v[84:99], v[128:131], v[80:83], v[84:99]
    v_exp_f32 v48, v48
    v_exp_f32 v49, v49
    v_exp_f32 v50, v50
    v_exp_f32 v51, v51
    v_cvt_pk_bf16_f32 v74, v48, v49
    v_cvt_pk_bf16_f32 v75, v50, v51
    s_waitcnt lgkmcnt(0)
    ds_read_b128 v[104:107], v132 offset:17024
    ds_read_b32 v112, v133 offset:17024
    ds_read_b128 v[124:127], v134 offset:12160
    ds_read_b128 v[128:131], v134 offset:12800
    v_mfma_f32_32x32x16_bf16 v[36:51], v[100:103], v[12:15], 0
    v_exp_f32 v52, v52
    v_exp_f32 v53, v53
    v_exp_f32 v54, v54
    v_exp_f32 v55, v55
    v_cvt_pk_bf16_f32 v76, v52, v53
    v_cvt_pk_bf16_f32 v77, v54, v55
    v_mfma_f32_32x32x16_bf16 v[84:99], v[116:119], v[68:71], v[84:99]
    v_exp_f32 v56, v56
    v_exp_f32 v57, v57
    v_exp_f32 v58, v58
    v_exp_f32 v59, v59
    v_cvt_pk_bf16_f32 v78, v56, v57
    v_cvt_pk_bf16_f32 v79, v58, v59
    v_mfma_f32_32x32x8_bf16 v[36:51], v[108:109], v[16:17], v[36:51]
    v_exp_f32 v60, v60
    v_exp_f32 v61, v61
    v_exp_f32 v62, v62
    v_exp_f32 v63, v63
    v_cvt_pk_bf16_f32 v80, v60, v61
    v_cvt_pk_bf16_f32 v81, v62, v63
    v_mfma_f32_32x32x16_bf16 v[84:99], v[120:123], v[72:75], v[84:99]
    v_exp_f32 v64, v64
    v_exp_f32 v65, v65
    v_exp_f32 v66, v66
    v_exp_f32 v67, v67
    v_cvt_pk_bf16_f32 v82, v64, v65
    v_cvt_pk_bf16_f32 v83, v66, v67
    s_waitcnt lgkmcnt(0)
    s_lshr_b32 s35, 17, s42
    s_and_b32 s35, s35, 1
    s_cbranch_scc0 attn_nobar1
    s_barrier
attn_nobar1:
    ds_read_b128 v[100:103], v132 offset:19456
    ds_read_b32 v108, v133 offset:19456
    ds_read_b128 v[116:119], v134 offset:14592
    ds_read_b128 v[120:123], v134 offset:15232
    v_mfma_f32_32x32x16_bf16 v[52:67], v[104:107], v[12:15], 0
    v_exp_f32 v36, v36
    v_exp_f32 v37, v37
    v_exp_f32 v38, v38
    v_exp_f32 v39, v39
    v_cvt_pk_bf16_f32 v68, v36, v37
    v_cvt_pk_bf16_f32 v69, v38, v39
    v_mfma_f32_32x32x16_bf16 v[84:99], v[124:127], v[76:79], v[84:99]
    v_exp_f32 v40, v40
    v_exp_f32 v41, v41
    v_exp_f32 v42, v42
    v_exp_f32 v43, v43
    v_cvt_pk_bf16_f32 v70, v40, v41
    v_cvt_pk_bf16_f32 v71, v42, v43
    v_mfma_f32_32x32x8_bf16 v[52:67], v[112:113], v[16:17], v[52:67]
    v_exp_f32 v44, v44
    v_exp_f32 v45, v45
    v_exp_f32 v46, v46
    v_exp_f32 v47, v47
    v_cvt_pk_bf16_f32 v72, v44, v45
    v_cvt_pk_bf16_f32 v73, v46, v47
    v_mfma_f32_32x32x16_bf16 v[84:99], v[128:131], v[80:83], v[84:99]
    v_exp_f32 v48, v48
    v_exp_f32 v49, v49
    v_exp_f32 v50, v50
    v_exp_f32 v51, v51
    v_cvt_pk_bf16_f32 v74, v48, v49
    v_cvt_pk_bf16_f32 v75, v50, v51
    s_waitcnt lgkmcnt(0)
    ds_read_b128 v[104:107], v132 offset:21888
    ds_read_b32 v112, v133 offset:21888
    ds_read_b128 v[124:127], v134 offset:17024
    ds_read_b128 v[128:131], v134 offset:17664
    v_mfma_f32_32x32x16_bf16 v[36:51], v[100:103], v[12:15], 0
    v_exp_f32 v52, v52
    v_exp_f32 v53, v53
    v_exp_f32 v54, v54
    v_exp_f32 v55, v55
    v_cvt_pk_bf16_f32 v76, v52, v53
    v_cvt_pk_bf16_f32 v77, v54, v55
    v_mfma_f32_32x32x16_bf16 v[84:99], v[116:119], v[68:71], v[84:99]
    v_exp_f32 v56, v56
    v_exp_f32 v57, v57
    v_exp_f32 v58, v58
    v_exp_f32 v59, v59
    v_cvt_pk_bf16_f32 v78, v56, v57
    v_cvt_pk_bf16_f32 v79, v58, v59
    v_mfma_f32_32x32x8_bf16 v[36:51], v[108:109], v[16:17], v[36:51]
    v_exp_f32 v60, v60
    v_exp_f32 v61, v61
    v_exp_f32 v62, v62
    v_exp_f32 v63, v63
    v_cvt_pk_bf16_f32 v80, v60, v61
    v_cvt_pk_bf16_f32 v81, v62, v63
    v_mfma_f32_32x32x16_bf16 v[84:99], v[120:123], v[72:75], v[84:99]
    v_exp_f32 v64, v64
    v_exp_f32 v65, v65
    v_exp_f32 v66, v66
    v_exp_f32 v67, v67
    v_cvt_pk_bf16_f32 v82, v64, v65
    v_cvt_pk_bf16_f32 v83, v66, v67
    v_add_u32 v132, 19456, v132
    v_add_u32 v133, 19456, v133
    v_add_u32 v134, 19456, v134
    s_add_u32 s42, s42, 1
    s_cmp_lt_u32 s42, 8
    s_cbranch_scc1 attn_loop1
    s_branch attn_done
attn_restart:
    v_mov_b32 v10, 0xff800000
    s_mov_b32 s42, 0
attn_maxloop:
    s_add_u32 s35, s42, 0
    buffer_load_dwordx4 v[100:103], v4, s[16:19], s35 offen offset:0 sc1
    buffer_load_dword v104, v5, s[16:19], s35 offen offset:0 sc1
    s_add_u32 s35, s42, 2432
    buffer_load_dwordx4 v[108:111], v4, s[16:19], s35 offen offset:0 sc1
    buffer_load_dword v112, v5, s[16:19], s35 offen offset:0 sc1
    s_add_u32 s35, s42, 4864
    buffer_load_dwordx4 v[116:119], v4, s[16:19], s35 offen offset:0 sc1
    buffer_load_dword v120, v5, s[16:19], s35 offen offset:0 sc1
    s_add_u32 s35, s42, 7296
    buffer_load_dwordx4 v[124:127], v4, s[16:19], s35 offen offset:0 sc1
    buffer_load_dword v128, v5, s[16:19], s35 offen offset:0 sc1
    v_mov_b32 v105, 0
    v_mov_b32 v113, 0
    v_mov_b32 v121, 0
    v_mov_b32 v129, 0
    s_waitcnt vmcnt(6)
    v_mfma_f32_32x32x16_bf16 v[36:51], v[100:103], v[12:15], 0
    s_waitcnt vmcnt(4)
    v_mfma_f32_32x32x16_bf16 v[52:67], v[108:111], v[12:15], 0
    s_waitcnt vmcnt(2)
    v_mfma_f32_32x32x16_bf16 v[68:83], v[116:119], v[12:15], 0
    s_waitcnt vmcnt(0)
    v_mfma_f32_32x32x16_bf16 v[84:99], v[124:127], v[12:15], 0
    s_nop 9
    v_mfma_f32_32x32x8_bf16 v[36:51], v[104:105], v[16:17], v[36:51]
    v_mfma_f32_32x32x8_bf16 v[52:67], v[112:113], v[16:17], v[52:67]
    v_mfma_f32_32x32x8_bf16 v[68:83], v[120:121], v[16:17], v[68:83]
    v_mfma_f32_32x32x8_bf16 v[84:99], v[128:129], v[16:17], v[84:99]
    s_nop 9
    v_max3_f32 v10, v36, v37, v10
    v_max3_f32 v10, v38, v39, v10
    v_max3_f32 v10, v40, v41, v10
    v_max3_f32 v10, v42, v43, v10
    v_max3_f32 v10, v44, v45, v10
    v_max3_f32 v10, v46, v47, v10
    v_max3_f32 v10, v48, v49, v10
    v_max3_f32 v10, v50, v51, v10
    v_max3_f32 v10, v52, v53, v10
    v_max3_f32 v10, v54, v55, v10
    v_max3_f32 v10, v56, v57, v10
    v_max3_f32 v10, v58, v59, v10
    v_max3_f32 v10, v60, v61, v10
    v_max3_f32 v10, v62, v63, v10
    v_max3_f32 v10, v64, v65, v10
    v_max3_f32 v10, v66, v67, v10
    v_max3_f32 v10, v68, v69, v10
    v_max3_f32 v10, v70, v71, v10
    v_max3_f32 v10, v72, v73, v10
    v_max3_f32 v10, v74, v75, v10
    v_max3_f32 v10, v76, v77, v10
    v_max3_f32 v10, v78, v79, v10
    v_max3_f32 v10, v80, v81, v10
    v_max3_f32 v10, v82, v83, v10
    s_nop 3
    v_max3_f32 v10, v84, v85, v10
    v_max3_f32 v10, v86, v87, v10
    v_max3_f32 v10, v88, v89, v10
    v_max3_f32 v10, v90, v91, v10
    v_max3_f32 v10, v92, v93, v10
    v_max3_f32 v10, v94, v95, v10
    v_max3_f32 v10, v96, v97, v10
    v_max3_f32 v10, v98, v99, v10
    s_add_u32 s42, s42, 9728
    s_cmp_lt_u32 s42, 155648
    s_cbranch_scc1 attn_maxloop
    v_mov_b32 v132, v4
    v_mov_b32 v133, v5
    v_mov_b32 v134, v6
    buffer_load_dwordx4 v[100:103], v4, s[16:19], 0 offen offset:0 sc1
    buffer_load_dword v108, v5, s[16:19], 0 offen offset:0 sc1
    buffer_load_dwordx4 v[104:107], v4, s[16:19], 0 offen offset:2432 sc1
    buffer_load_dword v112, v5, s[16:19], 0 offen offset:2432 sc1
    v_mov_b32 v11, v10
    s_nop 1
    v_permlane32_swap_b32 v10, v11
    v_max_f32 v10, v10, v11
    v_sub_f32 v10, 0, v10
    v_cvt_pk_bf16_f32 v20, v10, 0
    v_lshlrev_b32 v20, 16, v20
    v_sub_f32 v10, v10, v20
    v_cvt_pk_bf16_f32 v21, v10, 0
    v_lshlrev_b32 v21, 16, v21
    v_sub_f32 v10, v10, v21
    v_cmp_gt_u32 vcc, 32, v1
    v_cvt_pk_bf16_f32 v22, v20, v21
    v_cvt_pk_bf16_f32 v23, v10, 0
    v_cndmask_b32 v17, v23, v22, vcc
    v_mov_b32 v109, 0x3f803f80
    v_mov_b32 v113, 0x3f803f80
    s_waitcnt vmcnt(2)
    v_mfma_f32_32x32x16_bf16 v[36:51], v[100:103], v[12:15], 0
    v_mov_b32 v84, 0
    v_mov_b32 v85, 0
    v_mov_b32 v86, 0
    v_mov_b32 v87, 0
    v_mov_b32 v88, 0
    v_mov_b32 v89, 0
    v_mov_b32 v90, 0
    v_mov_b32 v91, 0
    v_mov_b32 v92, 0
    v_mov_b32 v93, 0
    v_mov_b32 v94, 0
    v_mov_b32 v95, 0
    v_mov_b32 v96, 0
    v_mov_b32 v97, 0
    v_mov_b32 v98, 0
    v_mov_b32 v99, 0
    v_mfma_f32_32x32x8_bf16 v[36:51], v[108:109], v[16:17], v[36:51]
    v_mov_b32 v76, 0
    v_mov_b32 v124, 0
    v_mov_b32 v77, 0
    v_mov_b32 v125, 0
    v_mov_b32 v78, 0
    v_mov_b32 v126, 0
    v_mov_b32 v79, 0
    v_mov_b32 v127, 0
    v_mov_b32 v80, 0
    v_mov_b32 v128, 0
    v_mov_b32 v81, 0
    v_mov_b32 v129, 0
    v_mov_b32 v82, 0
    v_mov_b32 v130, 0
    v_mov_b32 v83, 0
    v_mov_b32 v131, 0
    s_mov_b32 s42, 0
attn_loop2:
    s_waitcnt vmcnt(0)
    s_add_u32 s35, s42, 4864
    buffer_load_dwordx4 v[100:103], v4, s[16:19], s35 offen offset:0 sc1
    buffer_load_dword v108, v5, s[16:19], s35 offen offset:0 sc1
    buffer_load_dwordx4 v[116:119], v6, s[16:19], s42 offen offset:0 sc1
    buffer_load_dwordx4 v[120:123], v6, s[16:19], s42 offen offset:640 sc1
    s_add_u32 s42, s42, 2432
    v_mfma_f32_32x32x16_bf16 v[52:67], v[104:107], v[12:15], 0
    v_exp_f32 v36, v36
    v_exp_f32 v37, v37
    v_exp_f32 v38, v38
    v_exp_f32 v39, v39
    v_cvt_pk_bf16_f32 v68, v36, v37
    v_cvt_pk_bf16_f32 v69, v38, v39
    v_mfma_f32_32x32x16_bf16 v[84:99], v[124:127], v[76:79], v[84:99]
    v_exp_f32 v40, v40
    v_exp_f32 v41, v41
    v_exp_f32 v42, v42
    v_exp_f32 v43, v43
    v_cvt_pk_bf16_f32 v70, v40, v41
    v_cvt_pk_bf16_f32 v71, v42, v43
    v_mfma_f32_32x32x8_bf16 v[52:67], v[112:113], v[16:17], v[52:67]
    v_exp_f32 v44, v44
    v_exp_f32 v45, v45
    v_exp_f32 v46, v46
    v_exp_f32 v47, v47
    v_cvt_pk_bf16_f32 v72, v44, v45
    v_cvt_pk_bf16_f32 v73, v46, v47
    v_mfma_f32_32x32x16_bf16 v[84:99], v[128:131], v[80:83], v[84:99]
    v_exp_f32 v48, v48
    v_exp_f32 v49, v49
    v_exp_f32 v50, v50
    v_exp_f32 v51, v51
    v_cvt_pk_bf16_f32 v74, v48, v49
    v_cvt_pk_bf16_f32 v75, v50, v51
    s_waitcnt vmcnt(0)
    s_add_u32 s35, s42, 4864
    buffer_load_dwordx4 v[104:107], v4, s[16:19], s35 offen offset:0 sc1
    buffer_load_dword v112, v5, s[16:19], s35 offen offset:0 sc1
    buffer_load_dwordx4 v[124:127], v6, s[16:19], s42 offen offset:0 sc1
    buffer_load_dwordx4 v[128:131], v6, s[16:19], s42 offen offset:640 sc1
    s_add_u32 s42, s42, 2432
    v_mfma_f32_32x32x16_bf16 v[36:51], v[100:103], v[12:15], 0
    v_exp_f32 v52, v52
    v_exp_f32 v53, v53
    v_exp_f32 v54, v54
    v_exp_f32 v55, v55
    v_cvt_pk_bf16_f32 v76, v52, v53
    v_cvt_pk_bf16_f32 v77, v54, v55
    v_mfma_f32_32x32x16_bf16 v[84:99], v[116:119], v[68:71], v[84:99]
    v_exp_f32 v56, v56
    v_exp_f32 v57, v57
    v_exp_f32 v58, v58
    v_exp_f32 v59, v59
    v_cvt_pk_bf16_f32 v78, v56, v57
    v_cvt_pk_bf16_f32 v79, v58, v59
    v_mfma_f32_32x32x8_bf16 v[36:51], v[108:109], v[16:17], v[36:51]
    v_exp_f32 v60, v60
    v_exp_f32 v61, v61
    v_exp_f32 v62, v62
    v_exp_f32 v63, v63
    v_cvt_pk_bf16_f32 v80, v60, v61
    v_cvt_pk_bf16_f32 v81, v62, v63
    v_mfma_f32_32x32x16_bf16 v[84:99], v[120:123], v[72:75], v[84:99]
    v_exp_f32 v64, v64
    v_exp_f32 v65, v65
    v_exp_f32 v66, v66
    v_exp_f32 v67, v67
    v_cvt_pk_bf16_f32 v82, v64, v65
    v_cvt_pk_bf16_f32 v83, v66, v67
    s_cmp_lt_u32 s42, 155648
    s_cbranch_scc1 attn_loop2
    s_waitcnt vmcnt(0)
attn_done:
    s_waitcnt lgkmcnt(0)
    v_mfma_f32_32x32x16_bf16 v[84:99], v[124:127], v[76:79], v[84:99]
    v_mfma_f32_32x32x16_bf16 v[84:99], v[128:131], v[80:83], v[84:99]
    s_nop 15
    s_nop 3
    s_cmp_lg_u32 s40, 0
    s_cbranch_scc1 attn_fin
    v_mov_b32 v10, 0x71800000
    v_cmp_nlt_f32 vcc, v94, v10
    s_mov_b64 s[44:45], vcc
    v_mov_b32 v10, 0x207
    v_cmp_class_f32 vcc, v84, v10
    s_or_b64 s[44:45], s[44:45], vcc
    v_cmp_class_f32 vcc, v85, v10
    s_or_b64 s[44:45], s[44:45], vcc
    v_cmp_class_f32 vcc, v86, v10
    s_or_b64 s[44:45], s[44:45], vcc
    v_cmp_class_f32 vcc, v87, v10
    s_or_b64 s[44:45], s[44:45], vcc
    v_cmp_class_f32 vcc, v88, v10
    s_or_b64 s[44:45], s[44:45], vcc
    v_cmp_class_f32 vcc, v89, v10
    s_or_b64 s[44:45], s[44:45], vcc
    v_cmp_class_f32 vcc, v90, v10
    s_or_b64 s[44:45], s[44:45], vcc
    v_cmp_class_f32 vcc, v91, v10
    s_or_b64 s[44:45], s[44:45], vcc
    v_cmp_class_f32 vcc, v92, v10
    s_or_b64 s[44:45], s[44:45], vcc
    v_cmp_class_f32 vcc, v93, v10
    s_or_b64 s[44:45], s[44:45], vcc
    s_cmp_eq_u64 s[44:45], 0
    s_cbranch_scc1 attn_fin
    s_mov_b32 s40, 1
    s_branch attn_restart
attn_fin:
    v_rcp_f32 v10, v94
    s_nop 0
    v_mul_f32 v84, v84, v10
    v_mul_f32 v85, v85, v10
    v_mul_f32 v86, v86, v10
    v_mul_f32 v87, v87, v10
    v_mul_f32 v88, v88, v10
    v_mul_f32 v89, v89, v10
    v_mul_f32 v90, v90, v10
    v_mul_f32 v91, v91, v10
    v_mul_f32 v92, v92, v10
    v_mul_f32 v93, v93, v10
    v_cvt_pk_bf16_f32 v36, v84, v85
    v_cvt_pk_bf16_f32 v37, v86, v87
    v_cvt_pk_bf16_f32 v38, v88, v89
    v_cvt_pk_bf16_f32 v39, v90, v91
    v_cvt_pk_bf16_f32 v40, v92, v93
    s_nop 1
    v_permlane32_swap_b32 v36, v38
    v_permlane32_swap_b32 v37, v39
    buffer_store_dwordx4 v[36:39], v9, s[24:27], s36 offen sc1
    v_cmp_gt_u32 vcc, 32, v1
    s_and_saveexec_b64 s[44:45], vcc
    buffer_store_dword v40, v8, s[24:27], s36 offen offset:32 sc1
    s_mov_b64 exec, -1
    s_branch p2_done
attn_helper:
    s_sub_u32 s41, s32, 8
    s_lshl_b32 s34, s41, 10
    s_add_u32 m0, s34, 0
    s_add_u32 s35, s34, 0
    buffer_load_dwordx4 v7, s[16:19], s35 offen sc1 lds
    s_add_u32 m0, s34, 4096
    s_add_u32 s35, s34, 4096
    buffer_load_dwordx4 v7, s[16:19], s35 offen sc1 lds
    s_add_u32 m0, s34, 8192
    s_add_u32 s35, s34, 8192
    buffer_load_dwordx4 v7, s[16:19], s35 offen sc1 lds
    s_add_u32 m0, s34, 12288
    s_add_u32 s35, s34, 12288
    buffer_load_dwordx4 v7, s[16:19], s35 offen sc1 lds
    s_add_u32 m0, s34, 16384
    s_add_u32 s35, s34, 16384
    buffer_load_dwordx4 v7, s[16:19], s35 offen sc1 lds
    s_add_u32 m0, s34, 20480
    s_add_u32 s35, s34, 20480
    buffer_load_dwordx4 v7, s[16:19], s35 offen sc1 lds
    v_mov_b32 v4, 163832
    v_mov_b32 v5, 0
    ds_write_b32 v4, v5
    s_waitcnt vmcnt(0) lgkmcnt(0)
    s_barrier
    s_add_u32 m0, s34, 24576
    s_add_u32 s35, s34, 24576
    buffer_load_dwordx4 v7, s[16:19], s35 offen sc1 lds
    s_add_u32 m0, s34, 28672
    s_add_u32 s35, s34, 28672
    buffer_load_dwordx4 v7, s[16:19], s35 offen sc1 lds
    s_add_u32 m0, s34, 32768
    s_add_u32 s35, s34, 32768
    buffer_load_dwordx4 v7, s[16:19], s35 offen sc1 lds
    s_add_u32 m0, s34, 36864
    s_add_u32 s35, s34, 36864
    buffer_load_dwordx4 v7, s[16:19], s35 offen sc1 lds
    s_add_u32 m0, s34, 40960
    s_add_u32 s35, s34, 40960
    buffer_load_dwordx4 v7, s[16:19], s35 offen sc1 lds
    s_add_u32 m0, s34, 45056
    s_add_u32 s35, s34, 45056
    buffer_load_dwordx4 v7, s[16:19], s35 offen sc1 lds
    s_add_u32 m0, s34, 49152
    s_add_u32 s35, s34, 49152
    buffer_load_dwordx4 v7, s[16:19], s35 offen sc1 lds
    s_add_u32 m0, s34, 53248
    s_add_u32 s35, s34, 53248
    buffer_load_dwordx4 v7, s[16:19], s35 offen sc1 lds
    s_add_u32 m0, s34, 57344
    s_add_u32 s35, s34, 57344
    buffer_load_dwordx4 v7, s[16:19], s35 offen sc1 lds
    s_add_u32 m0, s34, 61440
    s_add_u32 s35, s34, 61440
    buffer_load_dwordx4 v7, s[16:19], s35 offen sc1 lds
    s_add_u32 m0, s34, 65536
    s_add_u32 s35, s34, 65536
    buffer_load_dwordx4 v7, s[16:19], s35 offen sc1 lds
    s_add_u32 m0, s34, 69632
    s_add_u32 s35, s34, 69632
    buffer_load_dwordx4 v7, s[16:19], s35 offen sc1 lds
    s_add_u32 m0, s34, 73728
    s_add_u32 s35, s34, 73728
    buffer_load_dwordx4 v7, s[16:19], s35 offen sc1 lds
    s_add_u32 m0, s34, 77824
    s_add_u32 s35, s34, 77824
    buffer_load_dwordx4 v7, s[16:19], s35 offen sc1 lds
    s_add_u32 m0, s34, 81920
    s_add_u32 s35, s34, 81920
    buffer_load_dwordx4 v7, s[16:19], s35 offen sc1 lds
    s_add_u32 m0, s34, 86016
    s_add_u32 s35, s34, 86016
    buffer_load_dwordx4 v7, s[16:19], s35 offen sc1 lds
    s_add_u32 m0, s34, 90112
    s_add_u32 s35, s34, 90112
    buffer_load_dwordx4 v7, s[16:19], s35 offen sc1 lds
    s_add_u32 m0, s34, 94208
    s_add_u32 s35, s34, 94208
    buffer_load_dwordx4 v7, s[16:19], s35 offen sc1 lds
    s_add_u32 m0, s34, 98304
    s_add_u32 s35, s34, 98304
    buffer_load_dwordx4 v7, s[16:19], s35 offen sc1 lds
    s_add_u32 m0, s34, 102400
    s_add_u32 s35, s34, 102400
    buffer_load_dwordx4 v7, s[16:19], s35 offen sc1 lds
    s_add_u32 s8, s4, 0
    s_addc_u32 s9, s5, 0
    s_mov_b32 s10, 7077888
    s_mov_b32 s11, 0x00020000
    s_add_u32 s20, s4, 11534336
    s_addc_u32 s21, s5, 0
    s_mov_b32 s22, 2359296
    s_mov_b32 s23, 0x00020000
    s_mov_b32 s12, s46
    s_mov_b32 s13, s47
    s_mov_b32 s14, 663552
    s_mov_b32 s15, 0x00020000
    s_mov_b32 s24, s48
    s_mov_b32 s25, s49
    s_mov_b32 s26, 663552
    s_mov_b32 s27, 0x00020000
    s_lshl_b32 s40, s41, 1
    s_add_u32 s40, s40, s33
    s_add_u32 s42, s40, 2
    s_mov_b32 s38, 0x3eae1a93
    s_waitcnt vmcnt(0)
    s_barrier
    v_lshrrev_b32 v10, 2, v1
    v_and_b32 v11, 3, v1
    v_bfe_u32 v12, v10, 1, 2
    v_xor_b32 v12, v12, v11
    v_lshlrev_b32 v12, 4, v12
    v_lshlrev_b32 v13, 6, v10
    v_add_u32 v12, v12, v13
    s_mul_i32 s39, s41, 12288
    s_add_u32 s39, s39, 106496
    v_add_u32 v12, s39, v12
    ds_read_b128 v[20:23], v12 offset:0
    ds_read_b128 v[24:27], v12 offset:1024
    ds_read_b128 v[28:31], v12 offset:2048
    ds_read_b128 v[32:35], v12 offset:3072
    ds_read_b128 v[36:39], v12 offset:4096
    ds_read_b128 v[40:43], v12 offset:5120
    ds_read_b128 v[44:47], v12 offset:6144
    ds_read_b128 v[48:51], v12 offset:7168
    ds_read_b128 v[52:55], v12 offset:8192
    ds_read_b128 v[56:59], v12 offset:9216
    ds_read_b128 v[60:63], v12 offset:10240
    ds_read_b128 v[64:67], v12 offset:11264
    s_lshl_b32 s35, s61, 7
    s_lshl_b32 s36, s41, 5
    s_add_u32 s35, s35, s36
    v_add_u32 v10, s35, v10
    v_mul_u32_u24 v10, 3456, v10
    v_lshlrev_b32 v11, 4, v11
    v_add_u32 v10, v10, v11
    s_mul_i32 s35, s62, 384
    v_add_u32 v10, s35, v10
    s_waitcnt lgkmcnt(0)
    s_add_u32 m0, s39, 0
    s_add_u32 s35, s39, 0
    buffer_load_dwordx4 v7, s[16:19], s35 offen sc1 lds
    s_add_u32 m0, s39, 1024
    s_add_u32 s35, s39, 1024
    buffer_load_dwordx4 v7, s[16:19], s35 offen sc1 lds
    s_add_u32 m0, s39, 2048
    s_add_u32 s35, s39, 2048
    buffer_load_dwordx4 v7, s[16:19], s35 offen sc1 lds
    s_add_u32 m0, s39, 3072
    s_add_u32 s35, s39, 3072
    buffer_load_dwordx4 v7, s[16:19], s35 offen sc1 lds
    s_add_u32 m0, s39, 4096
    s_add_u32 s35, s39, 4096
    buffer_load_dwordx4 v7, s[16:19], s35 offen sc1 lds
    s_add_u32 m0, s39, 5120
    s_add_u32 s35, s39, 5120
    buffer_load_dwordx4 v7, s[16:19], s35 offen sc1 lds
    s_add_u32 m0, s39, 6144
    s_add_u32 s35, s39, 6144
    buffer_load_dwordx4 v7, s[16:19], s35 offen sc1 lds
    s_add_u32 m0, s39, 7168
    s_add_u32 s35, s39, 7168
    buffer_load_dwordx4 v7, s[16:19], s35 offen sc1 lds
    s_add_u32 m0, s39, 8192
    s_add_u32 s35, s39, 8192
    buffer_load_dwordx4 v7, s[16:19], s35 offen sc1 lds
    s_add_u32 m0, s39, 9216
    s_add_u32 s35, s39, 9216
    buffer_load_dwordx4 v7, s[16:19], s35 offen sc1 lds
    s_add_u32 m0, s39, 10240
    s_add_u32 s35, s39, 10240
    buffer_load_dwordx4 v7, s[16:19], s35 offen sc1 lds
    s_add_u32 m0, s39, 11264
    s_add_u32 s35, s39, 11264
    buffer_load_dwordx4 v7, s[16:19], s35 offen sc1 lds
    s_mov_b32 s56, s8
    s_mov_b32 s57, s9
    s_mov_b32 s59, 0x00020000
    s_cmp_eq_u32 s60, 1
    s_cselect_b32 s58, 7077888, 0
    s_mov_b32 s36, 55296
    buffer_store_dwordx4 v[20:23], v10, s[56:59], 0 offen offset:0 sc1
    buffer_store_dwordx4 v[24:27], v10, s[56:59], s36 offen offset:0 sc1
    buffer_store_dwordx4 v[28:31], v10, s[56:59], 0 offen offset:64 sc1
    buffer_store_dwordx4 v[32:35], v10, s[56:59], s36 offen offset:64 sc1
    buffer_store_dwordx4 v[36:39], v10, s[56:59], 0 offen offset:128 sc1
    buffer_store_dwordx4 v[40:43], v10, s[56:59], s36 offen offset:128 sc1
    buffer_store_dwordx4 v[44:47], v10, s[56:59], 0 offen offset:192 sc1
    buffer_store_dwordx4 v[48:51], v10, s[56:59], s36 offen offset:192 sc1
    buffer_store_dwordx4 v[52:55], v10, s[56:59], 0 offen offset:256 sc1
    buffer_store_dwordx4 v[56:59], v10, s[56:59], s36 offen offset:256 sc1
    buffer_store_dwordx4 v[60:63], v10, s[56:59], 0 offen offset:320 sc1
    buffer_store_dwordx4 v[64:67], v10, s[56:59], s36 offen offset:320 sc1
    s_waitcnt vmcnt(0)
    s_add_u32 s50, s4, 11010048
    s_addc_u32 s51, s5, 0
    s_cmp_lg_u32 s60, 1
    s_cbranch_scc1 attn_h_nopub
    s_lshl_b32 s35, s61, 8
    s_lshl_b32 s39, s62, 4
    s_add_u32 s35, s35, s39
    s_lshl_b32 s39, s41, 2
    s_add_u32 s35, s35, s39
    v_mov_b32 v10, s35
    v_mov_b32 v11, 1
    s_mov_b64 exec, 1
    global_store_dword v10, v11, s[50:51] sc1
    s_mov_b64 exec, -1
attn_h_nopub:
    s_lshl_b32 s39, s6, 2
    s_add_u32 s39, s39, s41
    s_mul_i32 s39, s39, 5248
    v_min_u32 v24, 40, v1
    v_lshlrev_b32 v24, 7, v24
    buffer_load_dword v155, v24, s[12:15], s39 offen
    buffer_load_dword v155, v24, s[24:27], s39 offen
    s_barrier
    s_setprio 1
    s_sub_u32 s35, s33, 14
    s_max_i32 s35, s35, 0
    s_lshr_b32 s35, s35, 7
    s_lshl_b32 s35, s35, 8
    s_lshr_b32 s39, s33, 7
    s_lshl_b32 s39, s39, 8
    v_min_u32 v12, 35, v1
    v_lshlrev_b32 v12, 2, v12
    v_add_u32 v10, s35, v12
    v_add_u32 v12, s39, v12
    s_mov_b32 s43, 0
attn_poll:
    global_load_dword v11, v10, s[50:51] sc1
    global_load_dword v13, v12, s[50:51] sc1
    s_waitcnt vmcnt(0)
    v_and_b32 v11, v11, v13
    v_cmp_ne_u32 vcc, 1, v11
    s_add_u32 s43, s43, 1
    s_cmp_eq_u64 vcc, 0
    s_cbranch_scc1 attn_pollok
    s_sleep 16
    s_cmp_lt_u32 s43, 0x10000
    s_cbranch_scc1 attn_poll
attn_pollok:
    s_sub_u32 s39, s33, 14
    s_max_i32 s39, s39, 0
    s_mul_i32 s43, s39, 3456
    s_add_u32 s43, s43, s34
    s_add_u32 m0, s34, 0
    s_add_u32 s35, s43, 0
    buffer_load_dwordx4 v7, s[8:11], s35 offen sc1 lds
    s_add_u32 m0, s34, 4096
    s_add_u32 s35, s43, 4096
    buffer_load_dwordx4 v7, s[8:11], s35 offen sc1 lds
    s_add_u32 m0, s34, 8192
    s_add_u32 s35, s43, 8192
    buffer_load_dwordx4 v7, s[8:11], s35 offen sc1 lds
    s_add_u32 m0, s34, 12288
    s_add_u32 s35, s43, 12288
    buffer_load_dwordx4 v7, s[8:11], s35 offen sc1 lds
    s_add_u32 m0, s34, 16384
    s_add_u32 s35, s43, 16384
    buffer_load_dwordx4 v7, s[8:11], s35 offen sc1 lds
    s_add_u32 m0, s34, 20480
    s_add_u32 s35, s43, 20480
    buffer_load_dwordx4 v7, s[8:11], s35 offen sc1 lds
    s_add_u32 m0, s34, 24576
    s_add_u32 s35, s43, 24576
    buffer_load_dwordx4 v7, s[8:11], s35 offen sc1 lds
    s_add_u32 m0, s34, 28672
    s_add_u32 s35, s43, 28672
    buffer_load_dwordx4 v7, s[8:11], s35 offen sc1 lds
    s_add_u32 m0, s34, 32768
    s_add_u32 s35, s43, 32768
    buffer_load_dwordx4 v7, s[8:11], s35 offen sc1 lds
    s_add_u32 m0, s34, 36864
    s_add_u32 s35, s43, 36864
    buffer_load_dwordx4 v7, s[8:11], s35 offen sc1 lds
    s_add_u32 m0, s34, 40960
    s_add_u32 s35, s43, 40960
    buffer_load_dwordx4 v7, s[8:11], s35 offen sc1 lds
    s_add_u32 m0, s34, 45056
    s_add_u32 s35, s43, 45056
    buffer_load_dwordx4 v7, s[8:11], s35 offen sc1 lds
    s_add_u32 m0, s34, 49152
    s_add_u32 s35, s43, 49152
    buffer_load_dwordx4 v7, s[8:11], s35 offen sc1 lds
    s_add_u32 m0, s34, 53248
    s_add_u32 s35, s43, 53248
    buffer_load_dwordx4 v7, s[8:11], s35 offen sc1 lds
    s_add_u32 m0, s34, 57344
    s_add_u32 s35, s43, 57344
    buffer_load_dwordx4 v7, s[8:11], s35 offen sc1 lds
    s_add_u32 m0, s34, 61440
    s_add_u32 s35, s43, 61440
    buffer_load_dwordx4 v7, s[8:11], s35 offen sc1 lds
    s_add_u32 m0, s34, 65536
    s_add_u32 s35, s43, 65536
    buffer_load_dwordx4 v7, s[8:11], s35 offen sc1 lds
    s_add_u32 m0, s34, 69632
    s_add_u32 s35, s43, 69632
    buffer_load_dwordx4 v7, s[8:11], s35 offen sc1 lds
    s_add_u32 m0, s34, 73728
    s_add_u32 s35, s43, 73728
    buffer_load_dwordx4 v7, s[8:11], s35 offen sc1 lds
    s_movk_i32 s53, 1152
    s_waitcnt vmcnt(0)
    v_mov_b32 v5, 1
    s_mov_b64 exec, 1
    ds_add_u32 v4, v5
    s_mov_b64 exec, -1
attn_sb:
    ds_read_b32 v6, v4
    s_waitcnt lgkmcnt(0)
    v_readfirstlane_b32 s45, v6
    s_nop 3
    s_cmp_ge_u32 s45, 4
    s_cbranch_scc1 attn_sbx
    s_sleep 2
    s_branch attn_sb
attn_sbx:
attn_a_loop:
    v_lshlrev_b32 v10, 3, v3
    v_sub_u32 v10, s40, v10
    v_subrev_u32 v12, 0, v10
    v_max_i32 v11, 0, v12
    v_subrev_u32 v11, s39, v11
    v_mul_u32_u24 v11, 3456, v11
    v_add3_u32 v16, v11, v8, s53
    v_subrev_u32 v13, 2, v10
    v_max_i32 v11, 0, v13
    v_subrev_u32 v11, s39, v11
    v_mul_u32_u24 v11, 3456, v11
    v_add3_u32 v17, v11, v8, s53
    v_subrev_u32 v14, 4, v10
    v_max_i32 v11, 0, v14
    v_subrev_u32 v11, s39, v11
    v_mul_u32_u24 v11, 3456, v11
    v_add3_u32 v18, v11, v8, s53
    v_subrev_u32 v15, 6, v10
    v_max_i32 v11, 0, v15
    v_subrev_u32 v11, s39, v11
    v_mul_u32_u24 v11, 3456, v11
    v_add3_u32 v19, v11, v8, s53
    s_sub_u32 s35, s40, s39
    s_mul_i32 s35, s35, 3456
    v_add_u32 v11, s35, v8
    ds_read2_b32 v[20:21], v11 offset0:0 offset1:1
    ds_read2_b32 v[22:23], v11 offset0:2 offset1:3
    ds_read2_b32 v[24:25], v11 offset0:4 offset1:5
    ds_read2_b32 v[26:27], v11 offset0:6 offset1:7
    ds_read_b32 v28, v11 offset:32
    ds_read2_b32 v[30:31], v16 offset0:0 offset1:1
    ds_read2_b32 v[32:33], v16 offset0:2 offset1:3
    ds_read2_b32 v[34:35], v16 offset0:4 offset1:5
    ds_read2_b32 v[36:37], v16 offset0:6 offset1:7
    ds_read_b32 v38, v16 offset:32
    ds_read2_b32 v[40:41], v17 offset0:0 offset1:1
    ds_read2_b32 v[42:43], v17 offset0:2 offset1:3
    ds_read2_b32 v[44:45], v17 offset0:4 offset1:5
    ds_read2_b32 v[46:47], v17 offset0:6 offset1:7
    ds_read_b32 v48, v17 offset:32
    ds_read2_b32 v[50:51], v18 offset0:0 offset1:1
    ds_read2_b32 v[52:53], v18 offset0:2 offset1:3
    ds_read2_b32 v[54:55], v18 offset0:4 offset1:5
    ds_read2_b32 v[56:57], v18 offset0:6 offset1:7
    ds_read_b32 v58, v18 offset:32
    ds_read2_b32 v[60:61], v19 offset0:0 offset1:1
    ds_read2_b32 v[62:63], v19 offset0:2 offset1:3
    ds_read2_b32 v[64:65], v19 offset0:4 offset1:5
    ds_read2_b32 v[66:67], v19 offset0:6 offset1:7
    ds_read_b32 v68, v19 offset:32
    v_add_u32 v16, 1152, v16
    ds_read2_b32 v[70:71], v16 offset0:0 offset1:1
    ds_read2_b32 v[72:73], v16 offset0:2 offset1:3
    ds_read2_b32 v[74:75], v16 offset0:4 offset1:5
    ds_read2_b32 v[76:77], v16 offset0:6 offset1:7
    ds_read_b32 v78, v16 offset:32
    v_add_u32 v17, 1152, v17
    ds_read2_b32 v[80:81], v17 offset0:0 offset1:1
    ds_read2_b32 v[82:83], v17 offset0:2 offset1:3
    ds_read2_b32 v[84:85], v17 offset0:4 offset1:5
    ds_read2_b32 v[86:87], v17 offset0:6 offset1:7
    ds_read_b32 v88, v17 offset:32
    v_add_u32 v18, 1152, v18
    ds_read2_b32 v[90:91], v18 offset0:0 offset1:1
    ds_read2_b32 v[92:93], v18 offset0:2 offset1:3
    ds_read2_b32 v[94:95], v18 offset0:4 offset1:5
    ds_read2_b32 v[96:97], v18 offset0:6 offset1:7
    ds_read_b32 v98, v18 offset:32
    v_add_u32 v19, 1152, v19
    ds_read2_b32 v[100:101], v19 offset0:0 offset1:1
    ds_read2_b32 v[102:103], v19 offset0:2 offset1:3
    ds_read2_b32 v[104:105], v19 offset0:4 offset1:5
    ds_read2_b32 v[106:107], v19 offset0:6 offset1:7
    ds_read_b32 v108, v19 offset:32
    s_waitcnt lgkmcnt(0)
    v_dot2_f32_bf16 v134, v20, v30, 0
    v_dot2_f32_bf16 v135, v20, v40, 0
    v_dot2_f32_bf16 v136, v20, v50, 0
    v_dot2_f32_bf16 v137, v20, v60, 0
    v_dot2_f32_bf16 v134, v21, v31, v134
    v_dot2_f32_bf16 v135, v21, v41, v135
    v_dot2_f32_bf16 v136, v21, v51, v136
    v_dot2_f32_bf16 v137, v21, v61, v137
    v_dot2_f32_bf16 v134, v22, v32, v134
    v_dot2_f32_bf16 v135, v22, v42, v135
    v_dot2_f32_bf16 v136, v22, v52, v136
    v_dot2_f32_bf16 v137, v22, v62, v137
    v_dot2_f32_bf16 v134, v23, v33, v134
    v_dot2_f32_bf16 v135, v23, v43, v135
    v_dot2_f32_bf16 v136, v23, v53, v136
    v_dot2_f32_bf16 v137, v23, v63, v137
    v_dot2_f32_bf16 v134, v24, v34, v134
    v_dot2_f32_bf16 v135, v24, v44, v135
    v_dot2_f32_bf16 v136, v24, v54, v136
    v_dot2_f32_bf16 v137, v24, v64, v137
    v_dot2_f32_bf16 v134, v25, v35, v134
    v_dot2_f32_bf16 v135, v25, v45, v135
    v_dot2_f32_bf16 v136, v25, v55, v136
    v_dot2_f32_bf16 v137, v25, v65, v137
    v_dot2_f32_bf16 v134, v26, v36, v134
    v_dot2_f32_bf16 v135, v26, v46, v135
    v_dot2_f32_bf16 v136, v26, v56, v136
    v_dot2_f32_bf16 v137, v26, v66, v137
    v_dot2_f32_bf16 v134, v27, v37, v134
    v_dot2_f32_bf16 v135, v27, v47, v135
    v_dot2_f32_bf16 v136, v27, v57, v136
    v_dot2_f32_bf16 v137, v27, v67, v137
    v_dot2_f32_bf16 v134, v28, v38, v134
    v_dot2_f32_bf16 v135, v28, v48, v135
    v_dot2_f32_bf16 v136, v28, v58, v136
    v_dot2_f32_bf16 v137, v28, v68, v137
    v_mov_b32 v138, 0xff800000
    s_nop 2
    v_mul_f32 v134, s38, v134
    v_cmp_gt_i32 vcc, 0, v12
    s_nop 1
    v_cndmask_b32 v134, v134, v138, vcc
    v_mul_f32 v135, s38, v135
    v_cmp_gt_i32 vcc, 0, v13
    s_nop 1
    v_cndmask_b32 v135, v135, v138, vcc
    v_mul_f32 v136, s38, v136
    v_cmp_gt_i32 vcc, 0, v14
    s_nop 1
    v_cndmask_b32 v136, v136, v138, vcc
    v_mul_f32 v137, s38, v137
    v_cmp_gt_i32 vcc, 0, v15
    s_nop 1
    v_cndmask_b32 v137, v137, v138, vcc
    v_max_f32 v139, v134, v135
    v_max3_f32 v139, v136, v137, v139
    v_mov_b32 v140, v139
    s_nop 1
    v_permlane32_swap_b32 v139, v140
    v_max_f32 v139, v139, v140
    v_sub_f32 v134, v134, v139
    v_sub_f32 v135, v135, v139
    v_sub_f32 v136, v136, v139
    v_sub_f32 v137, v137, v139
    v_exp_f32 v134, v134
    v_exp_f32 v135, v135
    v_exp_f32 v136, v136
    v_exp_f32 v137, v137
    s_nop 0
    v_add_f32 v141, v134, v135
    v_add_f32 v142, v136, v137
    v_add_f32 v141, v141, v142
    v_mov_b32 v142, v141
    s_nop 1
    v_permlane32_swap_b32 v141, v142
    v_add_f32 v141, v141, v142
    v_rcp_f32 v141, v141
    s_nop 0
    v_mul_f32 v134, v134, v141
    v_mul_f32 v135, v135, v141
    v_mul_f32 v136, v136, v141
    v_mul_f32 v137, v137, v141
    v_cvt_pk_bf16_f32 v144, v134, 0
    v_cvt_pk_bf16_f32 v148, 0, v134
    v_cvt_pk_bf16_f32 v145, v135, 0
    v_cvt_pk_bf16_f32 v149, 0, v135
    v_cvt_pk_bf16_f32 v146, v136, 0
    v_cvt_pk_bf16_f32 v150, 0, v136
    v_cvt_pk_bf16_f32 v147, v137, 0
    v_cvt_pk_bf16_f32 v151, 0, v137
    v_dot2_f32_bf16 v110, v70, v144, 0
    v_dot2_f32_bf16 v111, v70, v148, 0
    v_dot2_f32_bf16 v112, v71, v144, 0
    v_dot2_f32_bf16 v113, v71, v148, 0
    v_dot2_f32_bf16 v114, v72, v144, 0
    v_dot2_f32_bf16 v115, v72, v148, 0
    v_dot2_f32_bf16 v116, v73, v144, 0
    v_dot2_f32_bf16 v117, v73, v148, 0
    v_dot2_f32_bf16 v118, v74, v144, 0
    v_dot2_f32_bf16 v119, v74, v148, 0
    v_dot2_f32_bf16 v120, v75, v144, 0
    v_dot2_f32_bf16 v121, v75, v148, 0
    v_dot2_f32_bf16 v122, v76, v144, 0
    v_dot2_f32_bf16 v123, v76, v148, 0
    v_dot2_f32_bf16 v124, v77, v144, 0
    v_dot2_f32_bf16 v125, v77, v148, 0
    v_dot2_f32_bf16 v126, v78, v144, 0
    v_dot2_f32_bf16 v127, v78, v148, 0
    v_dot2_f32_bf16 v110, v80, v145, v110
    v_dot2_f32_bf16 v111, v80, v149, v111
    v_dot2_f32_bf16 v112, v81, v145, v112
    v_dot2_f32_bf16 v113, v81, v149, v113
    v_dot2_f32_bf16 v114, v82, v145, v114
    v_dot2_f32_bf16 v115, v82, v149, v115
    v_dot2_f32_bf16 v116, v83, v145, v116
    v_dot2_f32_bf16 v117, v83, v149, v117
    v_dot2_f32_bf16 v118, v84, v145, v118
    v_dot2_f32_bf16 v119, v84, v149, v119
    v_dot2_f32_bf16 v120, v85, v145, v120
    v_dot2_f32_bf16 v121, v85, v149, v121
    v_dot2_f32_bf16 v122, v86, v145, v122
    v_dot2_f32_bf16 v123, v86, v149, v123
    v_dot2_f32_bf16 v124, v87, v145, v124
    v_dot2_f32_bf16 v125, v87, v149, v125
    v_dot2_f32_bf16 v126, v88, v145, v126
    v_dot2_f32_bf16 v127, v88, v149, v127
    v_dot2_f32_bf16 v110, v90, v146, v110
    v_dot2_f32_bf16 v111, v90, v150, v111
    v_dot2_f32_bf16 v112, v91, v146, v112
    v_dot2_f32_bf16 v113, v91, v150, v113
    v_dot2_f32_bf16 v114, v92, v146, v114
    v_dot2_f32_bf16 v115, v92, v150, v115
    v_dot2_f32_bf16 v116, v93, v146, v116
    v_dot2_f32_bf16 v117, v93, v150, v117
    v_dot2_f32_bf16 v118, v94, v146, v118
    v_dot2_f32_bf16 v119, v94, v150, v119
    v_dot2_f32_bf16 v120, v95, v146, v120
    v_dot2_f32_bf16 v121, v95, v150, v121
    v_dot2_f32_bf16 v122, v96, v146, v122
    v_dot2_f32_bf16 v123, v96, v150, v123
    v_dot2_f32_bf16 v124, v97, v146, v124
    v_dot2_f32_bf16 v125, v97, v150, v125
    v_dot2_f32_bf16 v126, v98, v146, v126
    v_dot2_f32_bf16 v127, v98, v150, v127
    v_dot2_f32_bf16 v110, v100, v147, v110
    v_dot2_f32_bf16 v111, v100, v151, v111
    v_dot2_f32_bf16 v112, v101, v147, v112
    v_dot2_f32_bf16 v113, v101, v151, v113
    v_dot2_f32_bf16 v114, v102, v147, v114
    v_dot2_f32_bf16 v115, v102, v151, v115
    v_dot2_f32_bf16 v116, v103, v147, v116
    v_dot2_f32_bf16 v117, v103, v151, v117
    v_dot2_f32_bf16 v118, v104, v147, v118
    v_dot2_f32_bf16 v119, v104, v151, v119
    v_dot2_f32_bf16 v120, v105, v147, v120
    v_dot2_f32_bf16 v121, v105, v151, v121
    v_dot2_f32_bf16 v122, v106, v147, v122
    v_dot2_f32_bf16 v123, v106, v151, v123
    v_dot2_f32_bf16 v124, v107, v147, v124
    v_dot2_f32_bf16 v125, v107, v151, v125
    v_dot2_f32_bf16 v126, v108, v147, v126
    v_dot2_f32_bf16 v127, v108, v151, v127
    s_nop 2
    v_mov_b32 v134, v126
    v_mov_b32 v135, v127
    s_nop 2
    v_permlane32_swap_b32 v110, v118
    v_permlane32_swap_b32 v111, v119
    v_permlane32_swap_b32 v112, v120
    v_permlane32_swap_b32 v113, v121
    v_permlane32_swap_b32 v114, v122
    v_permlane32_swap_b32 v115, v123
    v_permlane32_swap_b32 v116, v124
    v_permlane32_swap_b32 v117, v125
    v_permlane32_swap_b32 v126, v134
    v_permlane32_swap_b32 v127, v135
    v_add_f32 v110, v110, v118
    v_add_f32 v111, v111, v119
    v_add_f32 v112, v112, v120
    v_add_f32 v113, v113, v121
    v_add_f32 v114, v114, v122
    v_add_f32 v115, v115, v123
    v_add_f32 v116, v116, v124
    v_add_f32 v117, v117, v125
    v_add_f32 v126, v126, v134
    v_add_f32 v127, v127, v135
    v_cvt_pk_bf16_f32 v128, v110, v111
    v_cvt_pk_bf16_f32 v129, v112, v113
    v_cvt_pk_bf16_f32 v130, v114, v115
    v_cvt_pk_bf16_f32 v131, v116, v117
    v_cvt_pk_bf16_f32 v132, v126, v127
    s_mul_i32 s36, s40, 1152
    buffer_store_dwordx4 v[128:131], v9, s[20:23], s36 offen sc1
    buffer_store_dword v132, v8, s[20:23], s36 offen offset:32 sc1
    s_add_u32 s40, s40, 1
    s_cmp_lt_u32 s40, s42
    s_cbranch_scc1 attn_a_loop
    s_waitcnt vmcnt(0)
    s_lshr_b32 s35, s33, 7
    s_lshl_b32 s35, s35, 8
    s_and_b32 s36, s6, 15
    s_lshl_b32 s36, s36, 4
    s_add_u32 s35, s35, s36
    s_lshl_b32 s36, s41, 2
    s_add_u32 s35, s35, s36
    s_add_u32 s35, s35, 24576
    v_mov_b32 v10, s35
    v_mov_b32 v11, 1
    s_mov_b64 exec, 1
    global_store_dword v10, v11, s[50:51] sc1
    s_mov_b64 exec, -1
    s_setprio 0
p2_done:
    s_waitcnt vmcnt(0)
    s_barrier
    s_cmp_lg_u32 s32, 8
    s_cbranch_scc1 p2_wait
    s_add_u32 s50, s4, 11014144
    s_addc_u32 s51, s5, 0
    s_and_b32 s35, s2, 7
    s_lshl_b32 s35, s35, 1
    s_lshr_b32 s36, s2, 7
    s_add_u32 s36, s36, s35
    s_lshl_b32 s36, s36, 8
    s_bfe_u32 s37, s2, 0x40003
    s_lshl_b32 s37, s37, 2
    s_add_u32 s36, s36, s37
    v_mov_b32 v4, s36
    v_mov_b32 v5, 1
    s_mov_b64 exec, 1
    global_store_dword v4, v5, s[50:51] sc1
    s_mov_b64 exec, -1
    s_cmp_ge_u32 s2, 240
    s_cbranch_scc1 p2_wait
    s_bfe_u32 s36, s2, 0x10003
    s_add_u32 s35, s35, s36
    s_lshl_b32 s35, s35, 8
    s_cmp_lt_u32 s2, 144
    s_cselect_b32 s36, 15, 63
    s_cselect_b32 s37, 0, 20480
    s_add_u32 s35, s35, s37
    v_and_b32 v4, s36, v0
    v_lshlrev_b32 v4, 2, v4
    v_add_u32 v4, s35, v4
    s_mov_b32 s43, 0
p2_poll:
    global_load_dword v7, v4, s[50:51] sc1
    s_waitcnt vmcnt(0)
    v_cmp_ne_u32 vcc, 1, v7
    s_add_u32 s43, s43, 1
    s_cmp_eq_u64 vcc, 0
    s_cbranch_scc1 p2_ok
    s_sleep 4
    s_cmp_lt_u32 s43, 0x10000
    s_cbranch_scc1 p2_poll
p2_ok:
p2_wait:
    s_cmp_ge_u32 s2, 240
    s_cbranch_scc1 p3_done
    s_load_dwordx2 s[52:53], s[0:1], 16
    s_load_dwordx2 s[54:55], s[0:1], 56
    s_load_dwordx2 s[56:57], s[0:1], 64
    s_and_b32 s6, s2, 7
    s_lshr_b32 s7, s2, 3
    s_and_b32 s3, s7, 1
    s_lshl_b32 s40, s6, 1
    s_add_u32 s40, s40, s3
    s_lshr_b32 s41, s7, 1
    s_lshl_b32 s36, s40, 7
    s_movk_i32 s33, 1152
    s_movk_i32 s34, 2304
    s_mov_b32 s39, 3
    s_waitcnt lgkmcnt(0)
    s_mov_b32 s16, s56
    s_mov_b32 s17, s57
    s_mov_b32 s18, 4718592
    s_mov_b32 s19, 0x00020000
    s_barrier
    s_cmp_ge_u32 s41, 9
    s_cbranch_scc1 p3_A
    s_add_u32 s8, s4, 14680064
    s_addc_u32 s9, s5, 0
    s_mov_b32 s10, 2359296
    s_mov_b32 s11, 0x00020000
    s_mov_b32 s12, s54
    s_mov_b32 s13, s55
    s_mov_b32 s14, 663552
    s_mov_b32 s15, 0x00020000
    s_lshl_b32 s37, s41, 7
    s_add_u32 s38, s37, 1152
    s_mov_b32 s50, s41
    v_and_b32 v1, 63, v0
    v_lshrrev_b32 v13, 6, v0
    s_nop 0
    v_readfirstlane_b32 s32, v13
    s_nop 3
    s_cmp_lt_u32 s32, 4
    s_cbranch_scc1 ob_compute
    s_cmp_lt_u32 s32, 8
    s_cbranch_scc1 ob_loader
    s_waitcnt vmcnt(0)
    s_barrier
    s_barrier
    s_barrier
    s_barrier
    s_barrier
    s_barrier
    s_barrier
    s_barrier
    s_barrier
    s_barrier
    s_branch p3_done
ob_loader:
    s_sub_u32 s51, s32, 4
    v_lshrrev_b32 v13, 3, v1
    v_lshrrev_b32 v14, 4, v1
    v_and_b32 v15, 7, v1
    s_lshl_b32 s40, s51, 5
    s_add_u32 s40, s40, s36
    s_movk_i32 s41, 1152
    v_add_u32 v16, 0, v14
    v_and_b32 v16, 7, v16
    v_xor_b32 v16, v16, v15
    v_lshlrev_b32 v16, 4, v16
    v_add_u32 v17, 0, v13
    v_add_u32 v17, s40, v17
    v_mul_lo_u32 v17, v17, s41
    v_add_u32 v2, v16, v17
    v_add_u32 v16, 4, v14
    v_and_b32 v16, 7, v16
    v_xor_b32 v16, v16, v15
    v_lshlrev_b32 v16, 4, v16
    v_add_u32 v17, 8, v13
    v_add_u32 v17, s40, v17
    v_mul_lo_u32 v17, v17, s41
    v_add_u32 v3, v16, v17
    v_add_u32 v16, 8, v14
    v_and_b32 v16, 7, v16
    v_xor_b32 v16, v16, v15
    v_lshlrev_b32 v16, 4, v16
    v_add_u32 v17, 16, v13
    v_add_u32 v17, s40, v17
    v_mul_lo_u32 v17, v17, s41
    v_add_u32 v4, v16, v17
    v_add_u32 v16, 12, v14
    v_and_b32 v16, 7, v16
    v_xor_b32 v16, v16, v15
    v_lshlrev_b32 v16, 4, v16
    v_add_u32 v17, 24, v13
    v_add_u32 v17, s40, v17
    v_mul_lo_u32 v17, v17, s41
    v_add_u32 v5, v16, v17
    v_lshrrev_b32 v16, 2, v1
    s_lshl_b32 s40, s51, 4
    v_add_u32 v16, s40, v16
    v_mul_lo_u32 v16, v16, s33
    v_and_b32 v17, 3, v1
    v_lshlrev_b32 v17, 4, v17
    v_add_u32 v16, v16, v17
    v_add_u32 v6, s37, v16
    s_lshl_b32 s48, s33, 6
    s_mov_b32 s46, s50
    s_lshl_b32 s44, s51, 12
    s_lshl_b32 s45, s51, 10
    s_add_u32 s45, s45, 16384
    s_lshl_b32 s41, s46, 7
    s_mul_i32 s42, s46, s48
    s_add_u32 s46, s46, 1
    s_cmp_eq_u32 s46, 9
    s_cselect_b32 s46, 0, s46
    s_add_u32 m0, s44, 0
    s_nop 0
    buffer_load_dwordx4 v2, s[8:11], s41 offen sc1 lds
    s_add_u32 m0, s44, 1024
    s_nop 0
    buffer_load_dwordx4 v3, s[8:11], s41 offen sc1 lds
    s_add_u32 m0, s44, 2048
    s_nop 0
    buffer_load_dwordx4 v4, s[8:11], s41 offen sc1 lds
    s_add_u32 m0, s44, 3072
    s_nop 0
    buffer_load_dwordx4 v5, s[8:11], s41 offen sc1 lds
    s_add_u32 m0, s45, 0
    s_nop 0
    buffer_load_dwordx4 v6, s[12:15], s42 offen offset:0 lds
    s_add_u32 m0, s45, 4032
    s_nop 0
    buffer_load_dwordx4 v6, s[12:15], s42 offen offset:64 lds
    s_lshl_b32 s41, s46, 7
    s_mul_i32 s42, s46, s48
    s_add_u32 s46, s46, 1
    s_cmp_eq_u32 s46, 9
    s_cselect_b32 s46, 0, s46
    s_add_u32 m0, s44, 24576
    s_nop 0
    buffer_load_dwordx4 v2, s[8:11], s41 offen sc1 lds
    s_add_u32 m0, s44, 25600
    s_nop 0
    buffer_load_dwordx4 v3, s[8:11], s41 offen sc1 lds
    s_add_u32 m0, s44, 26624
    s_nop 0
    buffer_load_dwordx4 v4, s[8:11], s41 offen sc1 lds
    s_add_u32 m0, s44, 27648
    s_nop 0
    buffer_load_dwordx4 v5, s[8:11], s41 offen sc1 lds
    s_add_u32 m0, s45, 24576
    s_nop 0
    buffer_load_dwordx4 v6, s[12:15], s42 offen offset:0 lds
    s_add_u32 m0, s45, 28608
    s_nop 0
    buffer_load_dwordx4 v6, s[12:15], s42 offen offset:64 lds
    s_waitcnt vmcnt(6)
    s_barrier
    s_lshl_b32 s41, s46, 7
    s_mul_i32 s42, s46, s48
    s_add_u32 s46, s46, 1
    s_cmp_eq_u32 s46, 9
    s_cselect_b32 s46, 0, s46
    s_add_u32 m0, s44, 49152
    s_nop 0
    buffer_load_dwordx4 v2, s[8:11], s41 offen sc1 lds
    s_add_u32 m0, s44, 50176
    s_nop 0
    buffer_load_dwordx4 v3, s[8:11], s41 offen sc1 lds
    s_add_u32 m0, s44, 51200
    s_nop 0
    buffer_load_dwordx4 v4, s[8:11], s41 offen sc1 lds
    s_add_u32 m0, s44, 52224
    s_nop 0
    buffer_load_dwordx4 v5, s[8:11], s41 offen sc1 lds
    s_add_u32 m0, s45, 49152
    s_nop 0
    buffer_load_dwordx4 v6, s[12:15], s42 offen offset:0 lds
    s_add_u32 m0, s45, 53184
    s_nop 0
    buffer_load_dwordx4 v6, s[12:15], s42 offen offset:64 lds
    s_waitcnt vmcnt(6)
    s_barrier
    s_lshl_b32 s41, s46, 7
    s_mul_i32 s42, s46, s48
    s_add_u32 s46, s46, 1
    s_cmp_eq_u32 s46, 9
    s_cselect_b32 s46, 0, s46
    s_add_u32 m0, s44, 73728
    s_nop 0
    buffer_load_dwordx4 v2, s[8:11], s41 offen sc1 lds
    s_add_u32 m0, s44, 74752
    s_nop 0
    buffer_load_dwordx4 v3, s[8:11], s41 offen sc1 lds
    s_add_u32 m0, s44, 75776
    s_nop 0
    buffer_load_dwordx4 v4, s[8:11], s41 offen sc1 lds
    s_add_u32 m0, s44, 76800
    s_nop 0
    buffer_load_dwordx4 v5, s[8:11], s41 offen sc1 lds
    s_add_u32 m0, s45, 73728
    s_nop 0
    buffer_load_dwordx4 v6, s[12:15], s42 offen offset:0 lds
    s_add_u32 m0, s45, 77760
    s_nop 0
    buffer_load_dwordx4 v6, s[12:15], s42 offen offset:64 lds
    s_waitcnt vmcnt(6)
    s_barrier
    s_lshl_b32 s41, s46, 7
    s_mul_i32 s42, s46, s48
    s_add_u32 s46, s46, 1
    s_cmp_eq_u32 s46, 9
    s_cselect_b32 s46, 0, s46
    s_add_u32 m0, s44, 98304
    s_nop 0
    buffer_load_dwordx4 v2, s[8:11], s41 offen sc1 lds
    s_add_u32 m0, s44, 99328
    s_nop 0
    buffer_load_dwordx4 v3, s[8:11], s41 offen sc1 lds
    s_add_u32 m0, s44, 100352
    s_nop 0
    buffer_load_dwordx4 v4, s[8:11], s41 offen sc1 lds
    s_add_u32 m0, s44, 101376
    s_nop 0
    buffer_load_dwordx4 v5, s[8:11], s41 offen sc1 lds
    s_add_u32 m0, s45, 98304
    s_nop 0
    buffer_load_dwordx4 v6, s[12:15], s42 offen offset:0 lds
    s_add_u32 m0, s45, 102336
    s_nop 0
    buffer_load_dwordx4 v6, s[12:15], s42 offen offset:64 lds
    s_waitcnt vmcnt(6)
    s_barrier
    s_lshl_b32 s41, s46, 7
    s_mul_i32 s42, s46, s48
    s_add_u32 s46, s46, 1
    s_cmp_eq_u32 s46, 9
    s_cselect_b32 s46, 0, s46
    s_add_u32 m0, s44, 122880
    s_nop 0
    buffer_load_dwordx4 v2, s[8:11], s41 offen sc1 lds
    s_add_u32 m0, s44, 123904
    s_nop 0
    buffer_load_dwordx4 v3, s[8:11], s41 offen sc1 lds
    s_add_u32 m0, s44, 124928
    s_nop 0
    buffer_load_dwordx4 v4, s[8:11], s41 offen sc1 lds
    s_add_u32 m0, s44, 125952
    s_nop 0
    buffer_load_dwordx4 v5, s[8:11], s41 offen sc1 lds
    s_add_u32 m0, s45, 122880
    s_nop 0
    buffer_load_dwordx4 v6, s[12:15], s42 offen offset:0 lds
    s_add_u32 m0, s45, 126912
    s_nop 0
    buffer_load_dwordx4 v6, s[12:15], s42 offen offset:64 lds
    s_waitcnt vmcnt(6)
    s_barrier
    s_lshl_b32 s41, s46, 7
    s_mul_i32 s42, s46, s48
    s_add_u32 s46, s46, 1
    s_cmp_eq_u32 s46, 9
    s_cselect_b32 s46, 0, s46
    s_add_u32 m0, s44, 0
    s_nop 0
    buffer_load_dwordx4 v2, s[8:11], s41 offen sc1 lds
    s_add_u32 m0, s44, 1024
    s_nop 0
    buffer_load_dwordx4 v3, s[8:11], s41 offen sc1 lds
    s_add_u32 m0, s44, 2048
    s_nop 0
    buffer_load_dwordx4 v4, s[8:11], s41 offen sc1 lds
    s_add_u32 m0, s44, 3072
    s_nop 0
    buffer_load_dwordx4 v5, s[8:11], s41 offen sc1 lds
    s_add_u32 m0, s45, 0
    s_nop 0
    buffer_load_dwordx4 v6, s[12:15], s42 offen offset:0 lds
    s_add_u32 m0, s45, 4032
    s_nop 0
    buffer_load_dwordx4 v6, s[12:15], s42 offen offset:64 lds
    s_waitcnt vmcnt(6)
    s_barrier
    s_lshl_b32 s41, s46, 7
    s_mul_i32 s42, s46, s48
    s_add_u32 s46, s46, 1
    s_cmp_eq_u32 s46, 9
    s_cselect_b32 s46, 0, s46
    s_add_u32 m0, s44, 24576
    s_nop 0
    buffer_load_dwordx4 v2, s[8:11], s41 offen sc1 lds
    s_add_u32 m0, s44, 25600
    s_nop 0
    buffer_load_dwordx4 v3, s[8:11], s41 offen sc1 lds
    s_add_u32 m0, s44, 26624
    s_nop 0
    buffer_load_dwordx4 v4, s[8:11], s41 offen sc1 lds
    s_add_u32 m0, s44, 27648
    s_nop 0
    buffer_load_dwordx4 v5, s[8:11], s41 offen sc1 lds
    s_add_u32 m0, s45, 24576
    s_nop 0
    buffer_load_dwordx4 v6, s[12:15], s42 offen offset:0 lds
    s_add_u32 m0, s45, 28608
    s_nop 0
    buffer_load_dwordx4 v6, s[12:15], s42 offen offset:64 lds
    s_waitcnt vmcnt(6)
    s_barrier
    s_lshl_b32 s41, s46, 7
    s_mul_i32 s42, s46, s48
    s_add_u32 s46, s46, 1
    s_cmp_eq_u32 s46, 9
    s_cselect_b32 s46, 0, s46
    s_add_u32 m0, s44, 49152
    s_nop 0
    buffer_load_dwordx4 v2, s[8:11], s41 offen sc1 lds
    s_add_u32 m0, s44, 50176
    s_nop 0
    buffer_load_dwordx4 v3, s[8:11], s41 offen sc1 lds
    s_add_u32 m0, s44, 51200
    s_nop 0
    buffer_load_dwordx4 v4, s[8:11], s41 offen sc1 lds
    s_add_u32 m0, s44, 52224
    s_nop 0
    buffer_load_dwordx4 v5, s[8:11], s41 offen sc1 lds
    s_add_u32 m0, s45, 49152
    s_nop 0
    buffer_load_dwordx4 v6, s[12:15], s42 offen offset:0 lds
    s_add_u32 m0, s45, 53184
    s_nop 0
    buffer_load_dwordx4 v6, s[12:15], s42 offen offset:64 lds
    s_waitcnt vmcnt(6)
    s_barrier
    s_waitcnt vmcnt(0)
    s_barrier
    s_waitcnt vmcnt(0)
    s_barrier
    s_branch p3_done
ob_compute:
    v_bfe_u32 v13, v1, 2, 3
    s_mul_i32 s40, s6, 24
    s_add_u32 s40, s40, s36
    s_mul_i32 s41, s32, 6
    s_add_u32 s40, s40, s41
    v_add_u32 v14, s40, v13
    v_mul_u32_u24 v3, 1152, v14
    v_bfe_u32 v13, v1, 4, 2
    v_min_u32 v13, 3, v13
    s_mul_i32 s40, s3, 16
    s_mul_i32 s41, s32, 4
    s_add_u32 s40, s40, s41
    v_add_u32 v13, s40, v13
    v_mul_lo_u32 v13, v13, s33
    v_bfe_u32 v14, v1, 2, 2
    v_min_u32 v14, 1, v14
    v_lshlrev_b32 v14, 7, v14
    v_add_u32 v13, v13, v14
    v_add_u32 v4, s37, v13
    s_lshl_b32 s48, s33, 6
    s_movk_i32 s54, 256
    s_mul_i32 s55, s48, 2
    v_and_b32 v13, 31, v1
    v_lshrrev_b32 v14, 5, v1
    v_lshrrev_b32 v15, 1, v13
    v_and_b32 v15, 7, v15
    v_lshlrev_b32 v16, 7, v13
    s_lshl_b32 s40, s32, 12
    v_add_u32 v16, s40, v16
    v_lshlrev_b32 v17, 2, v14
    v_add_u32 v18, 0, v17
    v_xor_b32 v18, v18, v15
    v_lshlrev_b32 v18, 4, v18
    v_add_u32 v8, v16, v18
    v_add_u32 v18, 1, v17
    v_xor_b32 v18, v18, v15
    v_lshlrev_b32 v18, 4, v18
    v_add_u32 v9, v16, v18
    v_add_u32 v18, 2, v17
    v_xor_b32 v18, v18, v15
    v_lshlrev_b32 v18, 4, v18
    v_add_u32 v10, v16, v18
    v_add_u32 v18, 3, v17
    v_xor_b32 v18, v18, v15
    v_lshlrev_b32 v18, 4, v18
    v_add_u32 v11, v16, v18
    v_lshlrev_b32 v16, 11, v14
    v_bfe_u32 v17, v1, 2, 2
    v_lshlrev_b32 v17, 6, v17
    v_add_u32 v16, v16, v17
    v_bfe_u32 v17, v1, 4, 1
    v_lshlrev_b32 v17, 5, v17
    v_add_u32 v16, v16, v17
    v_and_b32 v17, 3, v1
    v_lshlrev_b32 v17, 3, v17
    v_add_u32 v16, v16, v17
    v_add_u32 v12, 16384, v16
    v_mov_b32 v64, 0
    v_mov_b32 v65, 0
    v_mov_b32 v66, 0
    v_mov_b32 v67, 0
    v_mov_b32 v68, 0
    v_mov_b32 v69, 0
    v_mov_b32 v70, 0
    v_mov_b32 v71, 0
    v_mov_b32 v72, 0
    v_mov_b32 v73, 0
    v_mov_b32 v74, 0
    v_mov_b32 v75, 0
    v_mov_b32 v76, 0
    v_mov_b32 v77, 0
    v_mov_b32 v78, 0
    v_mov_b32 v79, 0
    v_mov_b32 v80, 0
    v_mov_b32 v81, 0
    v_mov_b32 v82, 0
    v_mov_b32 v83, 0
    v_mov_b32 v84, 0
    v_mov_b32 v85, 0
    v_mov_b32 v86, 0
    v_mov_b32 v87, 0
    v_mov_b32 v88, 0
    v_mov_b32 v89, 0
    v_mov_b32 v90, 0
    v_mov_b32 v91, 0
    v_mov_b32 v92, 0
    v_mov_b32 v93, 0
    v_mov_b32 v94, 0
    v_mov_b32 v95, 0
    s_mov_b32 s7, 24576
    s_mov_b32 s40, 0
    s_mov_b32 s49, 0
    s_barrier
    ds_read_b128 v[16:19], v8
    ds_read_b64_tr_b16 v[20:21], v12 offset:0
    ds_read_b64_tr_b16 v[22:23], v12 offset:256
    ds_read_b64_tr_b16 v[24:25], v12 offset:4096
    ds_read_b64_tr_b16 v[26:27], v12 offset:4352
ob_loop:
    s_waitcnt lgkmcnt(2)
    v_mfma_f32_32x32x16_bf16 v[64:79], v[20:23], v[16:19], v[64:79]
    ds_read_b128 v[28:31], v9
    ds_read_b64_tr_b16 v[32:33], v12 offset:512
    ds_read_b64_tr_b16 v[34:35], v12 offset:768
    ds_read_b64_tr_b16 v[36:37], v12 offset:4608
    ds_read_b64_tr_b16 v[38:39], v12 offset:4864
    s_waitcnt lgkmcnt(5)
    v_mfma_f32_32x32x16_bf16 v[80:95], v[24:27], v[16:19], v[80:95]
    s_waitcnt lgkmcnt(2)
    v_mfma_f32_32x32x16_bf16 v[64:79], v[32:35], v[28:31], v[64:79]
    ds_read_b128 v[16:19], v10
    ds_read_b64_tr_b16 v[20:21], v12 offset:1024
    ds_read_b64_tr_b16 v[22:23], v12 offset:1280
    ds_read_b64_tr_b16 v[24:25], v12 offset:5120
    ds_read_b64_tr_b16 v[26:27], v12 offset:5376
    s_waitcnt lgkmcnt(5)
    v_mfma_f32_32x32x16_bf16 v[80:95], v[36:39], v[28:31], v[80:95]
    s_waitcnt lgkmcnt(2)
    v_mfma_f32_32x32x16_bf16 v[64:79], v[20:23], v[16:19], v[64:79]
    ds_read_b128 v[28:31], v11
    ds_read_b64_tr_b16 v[32:33], v12 offset:1536
    ds_read_b64_tr_b16 v[34:35], v12 offset:1792
    ds_read_b64_tr_b16 v[36:37], v12 offset:5632
    ds_read_b64_tr_b16 v[38:39], v12 offset:5888
    s_waitcnt lgkmcnt(5)
    v_mfma_f32_32x32x16_bf16 v[80:95], v[24:27], v[16:19], v[80:95]
    s_add_u32 s49, s49, 1
    s_cmp_eq_u32 s49, 6
    s_cselect_b32 s47, -122880, s7
    s_cselect_b32 s49, 0, s49
    v_add_u32 v8, s47, v8
    v_add_u32 v9, s47, v9
    v_add_u32 v10, s47, v10
    v_add_u32 v11, s47, v11
    v_add_u32 v12, s47, v12
    s_add_u32 s40, s40, 1
    s_cmp_lt_u32 s40, 9
    s_waitcnt lgkmcnt(0)
    v_mfma_f32_32x32x16_bf16 v[64:79], v[32:35], v[28:31], v[64:79]
    s_barrier
    ds_read_b128 v[16:19], v8
    ds_read_b64_tr_b16 v[20:21], v12 offset:0
    ds_read_b64_tr_b16 v[22:23], v12 offset:256
    ds_read_b64_tr_b16 v[24:25], v12 offset:4096
    ds_read_b64_tr_b16 v[26:27], v12 offset:4352
    v_mfma_f32_32x32x16_bf16 v[80:95], v[36:39], v[28:31], v[80:95]
    s_cbranch_scc1 ob_loop
    s_waitcnt vmcnt(0) lgkmcnt(0)
    s_nop 15
    s_nop 3
    v_and_b32 v13, 31, v1
    v_lshrrev_b32 v14, 5, v1
    v_mul_u32_u24 v15, 80, v13
    v_lshlrev_b32 v16, 3, v14
    v_add_u32 v15, v15, v16
    s_mul_i32 s40, s32, 5120
    v_add_u32 v15, s40, v15
    v_lshrrev_b32 v16, 2, v1
    v_mul_u32_u24 v17, 80, v16
    v_and_b32 v18, 3, v1
    v_lshlrev_b32 v18, 4, v18
    v_add_u32 v17, v17, v18
    v_add_u32 v17, s40, v17
    s_lshl_b32 s41, s32, 5
    s_add_u32 s41, s41, s36
    v_add_u32 v16, s41, v16
    v_mul_lo_u32 v16, v16, s34
    v_add_u32 v16, v16, v18
    v_add_u32 v16, s38, v16
    s_lshl_b32 s42, s34, 4
    v_cvt_pk_bf16_f32 v20, v64, v65
    v_cvt_pk_bf16_f32 v21, v66, v67
    v_cvt_pk_bf16_f32 v22, v68, v69
    v_cvt_pk_bf16_f32 v23, v70, v71
    v_cvt_pk_bf16_f32 v24, v72, v73
    v_cvt_pk_bf16_f32 v25, v74, v75
    v_cvt_pk_bf16_f32 v26, v76, v77
    v_cvt_pk_bf16_f32 v27, v78, v79
    ds_write_b64 v15, v[20:21] offset:0
    ds_write_b64 v15, v[22:23] offset:16
    ds_write_b64 v15, v[24:25] offset:32
    ds_write_b64 v15, v[26:27] offset:48
    v_cvt_pk_bf16_f32 v20, v80, v81
    v_cvt_pk_bf16_f32 v21, v82, v83
    v_cvt_pk_bf16_f32 v22, v84, v85
    v_cvt_pk_bf16_f32 v23, v86, v87
    v_cvt_pk_bf16_f32 v24, v88, v89
    v_cvt_pk_bf16_f32 v25, v90, v91
    v_cvt_pk_bf16_f32 v26, v92, v93
    v_cvt_pk_bf16_f32 v27, v94, v95
    ds_write_b64 v15, v[20:21] offset:2560
    ds_write_b64 v15, v[22:23] offset:2576
    ds_write_b64 v15, v[24:25] offset:2592
    ds_write_b64 v15, v[26:27] offset:2608
    s_waitcnt lgkmcnt(0)
    ds_read_b128 v[20:23], v17 offset:0
    ds_read_b128 v[24:27], v17 offset:1280
    ds_read_b128 v[28:31], v17 offset:2560
    ds_read_b128 v[32:35], v17 offset:3840
    s_waitcnt lgkmcnt(2)
    buffer_store_dwordx4 v[20:23], v16, s[16:19], 0 offen offset:0
    buffer_store_dwordx4 v[24:27], v16, s[16:19], s42 offen offset:0
    s_cmp_lt_u32 s39, 2
    s_cbranch_scc1 ob_skiplast
    s_waitcnt lgkmcnt(0)
    buffer_store_dwordx4 v[28:31], v16, s[16:19], 0 offen offset:64
    buffer_store_dwordx4 v[32:35], v16, s[16:19], s42 offen offset:64
ob_skiplast:
    s_branch p3_done
p3_A:
    s_sub_u32 s41, s41, 9
    s_add_u32 s8, s4, 11534336
    s_addc_u32 s9, s5, 0
    s_mov_b32 s10, 2359296
    s_mov_b32 s11, 0x00020000
    s_mov_b32 s12, s52
    s_mov_b32 s13, s53
    s_mov_b32 s14, 663552
    s_mov_b32 s15, 0x00020000
    s_mul_i32 s37, s41, 192
    s_mov_b32 s38, s37
    s_lshl_b32 s50, s3, 1
    s_add_u32 s50, s50, s41
    s_cmp_ge_u32 s50, 9
    s_cselect_b32 s51, 9, 0
    s_sub_u32 s50, s50, s51
    v_and_b32 v1, 63, v0
    v_lshrrev_b32 v13, 6, v0
    s_nop 0
    v_readfirstlane_b32 s32, v13
    s_nop 3
    s_cmp_lt_u32 s32, 4
    s_cbranch_scc1 og_compute
    s_cmp_lt_u32 s32, 8
    s_cbranch_scc1 og_loader
    s_waitcnt vmcnt(0)
    s_barrier
    s_barrier
    s_barrier
    s_barrier
    s_barrier
    s_barrier
    s_barrier
    s_barrier
    s_barrier
    s_barrier
    s_branch p3_done
og_loader:
    s_sub_u32 s51, s32, 4
    v_lshrrev_b32 v13, 3, v1
    v_lshrrev_b32 v14, 4, v1
    v_and_b32 v15, 7, v1
    s_lshl_b32 s40, s51, 5
    s_add_u32 s40, s40, s36
    s_movk_i32 s41, 1152
    v_add_u32 v16, 0, v14
    v_and_b32 v16, 7, v16
    v_xor_b32 v16, v16, v15
    v_lshlrev_b32 v16, 4, v16
    v_add_u32 v17, 0, v13
    v_add_u32 v17, s40, v17
    v_mul_lo_u32 v17, v17, s41
    v_add_u32 v2, v16, v17
    v_add_u32 v16, 4, v14
    v_and_b32 v16, 7, v16
    v_xor_b32 v16, v16, v15
    v_lshlrev_b32 v16, 4, v16
    v_add_u32 v17, 8, v13
    v_add_u32 v17, s40, v17
    v_mul_lo_u32 v17, v17, s41
    v_add_u32 v3, v16, v17
    v_add_u32 v16, 8, v14
    v_and_b32 v16, 7, v16
    v_xor_b32 v16, v16, v15
    v_lshlrev_b32 v16, 4, v16
    v_add_u32 v17, 16, v13
    v_add_u32 v17, s40, v17
    v_mul_lo_u32 v17, v17, s41
    v_add_u32 v4, v16, v17
    v_add_u32 v16, 12, v14
    v_and_b32 v16, 7, v16
    v_xor_b32 v16, v16, v15
    v_lshlrev_b32 v16, 4, v16
    v_add_u32 v17, 24, v13
    v_add_u32 v17, s40, v17
    v_mul_lo_u32 v17, v17, s41
    v_add_u32 v5, v16, v17
    v_lshrrev_b32 v16, 2, v1
    s_lshl_b32 s40, s51, 4
    v_add_u32 v16, s40, v16
    v_mul_lo_u32 v16, v16, s33
    v_and_b32 v17, 3, v1
    v_lshlrev_b32 v17, 4, v17
    v_add_u32 v16, v16, v17
    v_add_u32 v6, s37, v16
    s_lshl_b32 s48, s33, 6
    s_mov_b32 s46, s50
    s_lshl_b32 s44, s51, 12
    s_lshl_b32 s45, s51, 10
    s_add_u32 s45, s45, 16384
    s_lshl_b32 s41, s46, 7
    s_mul_i32 s42, s46, s48
    s_add_u32 s46, s46, 1
    s_cmp_eq_u32 s46, 9
    s_cselect_b32 s46, 0, s46
    s_add_u32 m0, s44, 0
    s_nop 0
    buffer_load_dwordx4 v2, s[8:11], s41 offen sc1 lds
    s_add_u32 m0, s44, 1024
    s_nop 0
    buffer_load_dwordx4 v3, s[8:11], s41 offen sc1 lds
    s_add_u32 m0, s44, 2048
    s_nop 0
    buffer_load_dwordx4 v4, s[8:11], s41 offen sc1 lds
    s_add_u32 m0, s44, 3072
    s_nop 0
    buffer_load_dwordx4 v5, s[8:11], s41 offen sc1 lds
    s_add_u32 m0, s45, 0
    s_nop 0
    buffer_load_dwordx4 v6, s[12:15], s42 offen offset:0 lds
    s_add_u32 m0, s45, 4032
    s_nop 0
    buffer_load_dwordx4 v6, s[12:15], s42 offen offset:64 lds
    s_add_u32 m0, s45, 8064
    s_nop 0
    buffer_load_dwordx4 v6, s[12:15], s42 offen offset:128 lds
    s_lshl_b32 s41, s46, 7
    s_mul_i32 s42, s46, s48
    s_add_u32 s46, s46, 1
    s_cmp_eq_u32 s46, 9
    s_cselect_b32 s46, 0, s46
    s_add_u32 m0, s44, 28672
    s_nop 0
    buffer_load_dwordx4 v2, s[8:11], s41 offen sc1 lds
    s_add_u32 m0, s44, 29696
    s_nop 0
    buffer_load_dwordx4 v3, s[8:11], s41 offen sc1 lds
    s_add_u32 m0, s44, 30720
    s_nop 0
    buffer_load_dwordx4 v4, s[8:11], s41 offen sc1 lds
    s_add_u32 m0, s44, 31744
    s_nop 0
    buffer_load_dwordx4 v5, s[8:11], s41 offen sc1 lds
    s_add_u32 m0, s45, 28672
    s_nop 0
    buffer_load_dwordx4 v6, s[12:15], s42 offen offset:0 lds
    s_add_u32 m0, s45, 32704
    s_nop 0
    buffer_load_dwordx4 v6, s[12:15], s42 offen offset:64 lds
    s_add_u32 m0, s45, 36736
    s_nop 0
    buffer_load_dwordx4 v6, s[12:15], s42 offen offset:128 lds
    s_waitcnt vmcnt(7)
    s_barrier
    s_lshl_b32 s41, s46, 7
    s_mul_i32 s42, s46, s48
    s_add_u32 s46, s46, 1
    s_cmp_eq_u32 s46, 9
    s_cselect_b32 s46, 0, s46
    s_add_u32 m0, s44, 57344
    s_nop 0
    buffer_load_dwordx4 v2, s[8:11], s41 offen sc1 lds
    s_add_u32 m0, s44, 58368
    s_nop 0
    buffer_load_dwordx4 v3, s[8:11], s41 offen sc1 lds
    s_add_u32 m0, s44, 59392
    s_nop 0
    buffer_load_dwordx4 v4, s[8:11], s41 offen sc1 lds
    s_add_u32 m0, s44, 60416
    s_nop 0
    buffer_load_dwordx4 v5, s[8:11], s41 offen sc1 lds
    s_add_u32 m0, s45, 57344
    s_nop 0
    buffer_load_dwordx4 v6, s[12:15], s42 offen offset:0 lds
    s_add_u32 m0, s45, 61376
    s_nop 0
    buffer_load_dwordx4 v6, s[12:15], s42 offen offset:64 lds
    s_add_u32 m0, s45, 65408
    s_nop 0
    buffer_load_dwordx4 v6, s[12:15], s42 offen offset:128 lds
    s_waitcnt vmcnt(7)
    s_barrier
    s_lshl_b32 s41, s46, 7
    s_mul_i32 s42, s46, s48
    s_add_u32 s46, s46, 1
    s_cmp_eq_u32 s46, 9
    s_cselect_b32 s46, 0, s46
    s_add_u32 m0, s44, 86016
    s_nop 0
    buffer_load_dwordx4 v2, s[8:11], s41 offen sc1 lds
    s_add_u32 m0, s44, 87040
    s_nop 0
    buffer_load_dwordx4 v3, s[8:11], s41 offen sc1 lds
    s_add_u32 m0, s44, 88064
    s_nop 0
    buffer_load_dwordx4 v4, s[8:11], s41 offen sc1 lds
    s_add_u32 m0, s44, 89088
    s_nop 0
    buffer_load_dwordx4 v5, s[8:11], s41 offen sc1 lds
    s_add_u32 m0, s45, 86016
    s_nop 0
    buffer_load_dwordx4 v6, s[12:15], s42 offen offset:0 lds
    s_add_u32 m0, s45, 90048
    s_nop 0
    buffer_load_dwordx4 v6, s[12:15], s42 offen offset:64 lds
    s_add_u32 m0, s45, 94080
    s_nop 0
    buffer_load_dwordx4 v6, s[12:15], s42 offen offset:128 lds
    s_waitcnt vmcnt(7)
    s_barrier
    s_lshl_b32 s41, s46, 7
    s_mul_i32 s42, s46, s48
    s_add_u32 s46, s46, 1
    s_cmp_eq_u32 s46, 9
    s_cselect_b32 s46, 0, s46
    s_add_u32 m0, s44, 114688
    s_nop 0
    buffer_load_dwordx4 v2, s[8:11], s41 offen sc1 lds
    s_add_u32 m0, s44, 115712
    s_nop 0
    buffer_load_dwordx4 v3, s[8:11], s41 offen sc1 lds
    s_add_u32 m0, s44, 116736
    s_nop 0
    buffer_load_dwordx4 v4, s[8:11], s41 offen sc1 lds
    s_add_u32 m0, s44, 117760
    s_nop 0
    buffer_load_dwordx4 v5, s[8:11], s41 offen sc1 lds
    s_add_u32 m0, s45, 114688
    s_nop 0
    buffer_load_dwordx4 v6, s[12:15], s42 offen offset:0 lds
    s_add_u32 m0, s45, 118720
    s_nop 0
    buffer_load_dwordx4 v6, s[12:15], s42 offen offset:64 lds
    s_add_u32 m0, s45, 122752
    s_nop 0
    buffer_load_dwordx4 v6, s[12:15], s42 offen offset:128 lds
    s_waitcnt vmcnt(7)
    s_barrier
    s_lshl_b32 s41, s46, 7
    s_mul_i32 s42, s46, s48
    s_add_u32 s46, s46, 1
    s_cmp_eq_u32 s46, 9
    s_cselect_b32 s46, 0, s46
    s_add_u32 m0, s44, 0
    s_nop 0
    buffer_load_dwordx4 v2, s[8:11], s41 offen sc1 lds
    s_add_u32 m0, s44, 1024
    s_nop 0
    buffer_load_dwordx4 v3, s[8:11], s41 offen sc1 lds
    s_add_u32 m0, s44, 2048
    s_nop 0
    buffer_load_dwordx4 v4, s[8:11], s41 offen sc1 lds
    s_add_u32 m0, s44, 3072
    s_nop 0
    buffer_load_dwordx4 v5, s[8:11], s41 offen sc1 lds
    s_add_u32 m0, s45, 0
    s_nop 0
    buffer_load_dwordx4 v6, s[12:15], s42 offen offset:0 lds
    s_add_u32 m0, s45, 4032
    s_nop 0
    buffer_load_dwordx4 v6, s[12:15], s42 offen offset:64 lds
    s_add_u32 m0, s45, 8064
    s_nop 0
    buffer_load_dwordx4 v6, s[12:15], s42 offen offset:128 lds
    s_waitcnt vmcnt(7)
    s_barrier
    s_lshl_b32 s41, s46, 7
    s_mul_i32 s42, s46, s48
    s_add_u32 s46, s46, 1
    s_cmp_eq_u32 s46, 9
    s_cselect_b32 s46, 0, s46
    s_add_u32 m0, s44, 28672
    s_nop 0
    buffer_load_dwordx4 v2, s[8:11], s41 offen sc1 lds
    s_add_u32 m0, s44, 29696
    s_nop 0
    buffer_load_dwordx4 v3, s[8:11], s41 offen sc1 lds
    s_add_u32 m0, s44, 30720
    s_nop 0
    buffer_load_dwordx4 v4, s[8:11], s41 offen sc1 lds
    s_add_u32 m0, s44, 31744
    s_nop 0
    buffer_load_dwordx4 v5, s[8:11], s41 offen sc1 lds
    s_add_u32 m0, s45, 28672
    s_nop 0
    buffer_load_dwordx4 v6, s[12:15], s42 offen offset:0 lds
    s_add_u32 m0, s45, 32704
    s_nop 0
    buffer_load_dwordx4 v6, s[12:15], s42 offen offset:64 lds
    s_add_u32 m0, s45, 36736
    s_nop 0
    buffer_load_dwordx4 v6, s[12:15], s42 offen offset:128 lds
    s_waitcnt vmcnt(7)
    s_barrier
    s_lshl_b32 s41, s46, 7
    s_mul_i32 s42, s46, s48
    s_add_u32 s46, s46, 1
    s_cmp_eq_u32 s46, 9
    s_cselect_b32 s46, 0, s46
    s_add_u32 m0, s44, 57344
    s_nop 0
    buffer_load_dwordx4 v2, s[8:11], s41 offen sc1 lds
    s_add_u32 m0, s44, 58368
    s_nop 0
    buffer_load_dwordx4 v3, s[8:11], s41 offen sc1 lds
    s_add_u32 m0, s44, 59392
    s_nop 0
    buffer_load_dwordx4 v4, s[8:11], s41 offen sc1 lds
    s_add_u32 m0, s44, 60416
    s_nop 0
    buffer_load_dwordx4 v5, s[8:11], s41 offen sc1 lds
    s_add_u32 m0, s45, 57344
    s_nop 0
    buffer_load_dwordx4 v6, s[12:15], s42 offen offset:0 lds
    s_add_u32 m0, s45, 61376
    s_nop 0
    buffer_load_dwordx4 v6, s[12:15], s42 offen offset:64 lds
    s_add_u32 m0, s45, 65408
    s_nop 0
    buffer_load_dwordx4 v6, s[12:15], s42 offen offset:128 lds
    s_waitcnt vmcnt(7)
    s_barrier
    s_lshl_b32 s41, s46, 7
    s_mul_i32 s42, s46, s48
    s_add_u32 s46, s46, 1
    s_cmp_eq_u32 s46, 9
    s_cselect_b32 s46, 0, s46
    s_add_u32 m0, s44, 86016
    s_nop 0
    buffer_load_dwordx4 v2, s[8:11], s41 offen sc1 lds
    s_add_u32 m0, s44, 87040
    s_nop 0
    buffer_load_dwordx4 v3, s[8:11], s41 offen sc1 lds
    s_add_u32 m0, s44, 88064
    s_nop 0
    buffer_load_dwordx4 v4, s[8:11], s41 offen sc1 lds
    s_add_u32 m0, s44, 89088
    s_nop 0
    buffer_load_dwordx4 v5, s[8:11], s41 offen sc1 lds
    s_add_u32 m0, s45, 86016
    s_nop 0
    buffer_load_dwordx4 v6, s[12:15], s42 offen offset:0 lds
    s_add_u32 m0, s45, 90048
    s_nop 0
    buffer_load_dwordx4 v6, s[12:15], s42 offen offset:64 lds
    s_add_u32 m0, s45, 94080
    s_nop 0
    buffer_load_dwordx4 v6, s[12:15], s42 offen offset:128 lds
    s_waitcnt vmcnt(7)
    s_barrier
    s_waitcnt vmcnt(0)
    s_barrier
    s_waitcnt vmcnt(0)
    s_barrier
    s_branch p3_done
og_compute:
    v_bfe_u32 v13, v1, 2, 3
    s_mul_i32 s40, s6, 24
    s_add_u32 s40, s40, s36
    s_mul_i32 s41, s32, 6
    s_add_u32 s40, s40, s41
    v_add_u32 v14, s40, v13
    v_mul_u32_u24 v3, 1152, v14
    v_bfe_u32 v13, v1, 4, 2
    v_min_u32 v13, 3, v13
    s_mul_i32 s40, s3, 16
    s_mul_i32 s41, s32, 4
    s_add_u32 s40, s40, s41
    v_add_u32 v13, s40, v13
    v_mul_lo_u32 v13, v13, s33
    v_bfe_u32 v14, v1, 2, 2
    v_min_u32 v14, 1, v14
    v_lshlrev_b32 v14, 7, v14
    v_add_u32 v13, v13, v14
    v_add_u32 v4, s37, v13
    s_lshl_b32 s48, s33, 6
    s_movk_i32 s54, 256
    s_mul_i32 s55, s48, 2
    v_and_b32 v13, 31, v1
    v_lshrrev_b32 v14, 5, v1
    v_lshrrev_b32 v15, 1, v13
    v_and_b32 v15, 7, v15
    v_lshlrev_b32 v16, 7, v13
    s_lshl_b32 s40, s32, 12
    v_add_u32 v16, s40, v16
    v_lshlrev_b32 v17, 2, v14
    v_add_u32 v18, 0, v17
    v_xor_b32 v18, v18, v15
    v_lshlrev_b32 v18, 4, v18
    v_add_u32 v8, v16, v18
    v_add_u32 v18, 1, v17
    v_xor_b32 v18, v18, v15
    v_lshlrev_b32 v18, 4, v18
    v_add_u32 v9, v16, v18
    v_add_u32 v18, 2, v17
    v_xor_b32 v18, v18, v15
    v_lshlrev_b32 v18, 4, v18
    v_add_u32 v10, v16, v18
    v_add_u32 v18, 3, v17
    v_xor_b32 v18, v18, v15
    v_lshlrev_b32 v18, 4, v18
    v_add_u32 v11, v16, v18
    v_lshlrev_b32 v16, 11, v14
    v_bfe_u32 v17, v1, 2, 2
    v_lshlrev_b32 v17, 6, v17
    v_add_u32 v16, v16, v17
    v_bfe_u32 v17, v1, 4, 1
    v_lshlrev_b32 v17, 5, v17
    v_add_u32 v16, v16, v17
    v_and_b32 v17, 3, v1
    v_lshlrev_b32 v17, 3, v17
    v_add_u32 v16, v16, v17
    v_add_u32 v12, 16384, v16
    v_mov_b32 v64, 0
    v_mov_b32 v65, 0
    v_mov_b32 v66, 0
    v_mov_b32 v67, 0
    v_mov_b32 v68, 0
    v_mov_b32 v69, 0
    v_mov_b32 v70, 0
    v_mov_b32 v71, 0
    v_mov_b32 v72, 0
    v_mov_b32 v73, 0
    v_mov_b32 v74, 0
    v_mov_b32 v75, 0
    v_mov_b32 v76, 0
    v_mov_b32 v77, 0
    v_mov_b32 v78, 0
    v_mov_b32 v79, 0
    v_mov_b32 v80, 0
    v_mov_b32 v81, 0
    v_mov_b32 v82, 0
    v_mov_b32 v83, 0
    v_mov_b32 v84, 0
    v_mov_b32 v85, 0
    v_mov_b32 v86, 0
    v_mov_b32 v87, 0
    v_mov_b32 v88, 0
    v_mov_b32 v89, 0
    v_mov_b32 v90, 0
    v_mov_b32 v91, 0
    v_mov_b32 v92, 0
    v_mov_b32 v93, 0
    v_mov_b32 v94, 0
    v_mov_b32 v95, 0
    v_mov_b32 v96, 0
    v_mov_b32 v97, 0
    v_mov_b32 v98, 0
    v_mov_b32 v99, 0
    v_mov_b32 v100, 0
    v_mov_b32 v101, 0
    v_mov_b32 v102, 0
    v_mov_b32 v103, 0
    v_mov_b32 v104, 0
    v_mov_b32 v105, 0
    v_mov_b32 v106, 0
    v_mov_b32 v107, 0
    v_mov_b32 v108, 0
    v_mov_b32 v109, 0
    v_mov_b32 v110, 0
    v_mov_b32 v111, 0
    s_mov_b32 s7, 28672
    s_mov_b32 s40, 0
    s_mov_b32 s49, 0
    s_barrier
    ds_read_b128 v[16:19], v8
    ds_read_b64_tr_b16 v[20:21], v12 offset:0
    ds_read_b64_tr_b16 v[22:23], v12 offset:256
    ds_read_b64_tr_b16 v[24:25], v12 offset:4096
    ds_read_b64_tr_b16 v[26:27], v12 offset:4352
    ds_read_b64_tr_b16 v[28:29], v12 offset:8192
    ds_read_b64_tr_b16 v[30:31], v12 offset:8448
og_loop:
    s_waitcnt lgkmcnt(4)
    v_mfma_f32_32x32x16_bf16 v[64:79], v[20:23], v[16:19], v[64:79]
    ds_read_b128 v[32:35], v9
    ds_read_b64_tr_b16 v[36:37], v12 offset:512
    ds_read_b64_tr_b16 v[38:39], v12 offset:768
    ds_read_b64_tr_b16 v[40:41], v12 offset:4608
    s_waitcnt lgkmcnt(6)
    v_mfma_f32_32x32x16_bf16 v[80:95], v[24:27], v[16:19], v[80:95]
    ds_read_b64_tr_b16 v[42:43], v12 offset:4864
    ds_read_b64_tr_b16 v[44:45], v12 offset:8704
    ds_read_b64_tr_b16 v[46:47], v12 offset:8960
    s_waitcnt lgkmcnt(7)
    v_mfma_f32_32x32x16_bf16 v[96:111], v[28:31], v[16:19], v[96:111]
    s_waitcnt lgkmcnt(4)
    v_mfma_f32_32x32x16_bf16 v[64:79], v[36:39], v[32:35], v[64:79]
    ds_read_b128 v[16:19], v10
    ds_read_b64_tr_b16 v[20:21], v12 offset:1024
    ds_read_b64_tr_b16 v[22:23], v12 offset:1280
    ds_read_b64_tr_b16 v[24:25], v12 offset:5120
    s_waitcnt lgkmcnt(6)
    v_mfma_f32_32x32x16_bf16 v[80:95], v[40:43], v[32:35], v[80:95]
    ds_read_b64_tr_b16 v[26:27], v12 offset:5376
    ds_read_b64_tr_b16 v[28:29], v12 offset:9216
    ds_read_b64_tr_b16 v[30:31], v12 offset:9472
    s_waitcnt lgkmcnt(7)
    v_mfma_f32_32x32x16_bf16 v[96:111], v[44:47], v[32:35], v[96:111]
    s_waitcnt lgkmcnt(4)
    v_mfma_f32_32x32x16_bf16 v[64:79], v[20:23], v[16:19], v[64:79]
    ds_read_b128 v[32:35], v11
    ds_read_b64_tr_b16 v[36:37], v12 offset:1536
    ds_read_b64_tr_b16 v[38:39], v12 offset:1792
    ds_read_b64_tr_b16 v[40:41], v12 offset:5632
    s_waitcnt lgkmcnt(6)
    v_mfma_f32_32x32x16_bf16 v[80:95], v[24:27], v[16:19], v[80:95]
    ds_read_b64_tr_b16 v[42:43], v12 offset:5888
    ds_read_b64_tr_b16 v[44:45], v12 offset:9728
    ds_read_b64_tr_b16 v[46:47], v12 offset:9984
    s_waitcnt lgkmcnt(7)
    v_mfma_f32_32x32x16_bf16 v[96:111], v[28:31], v[16:19], v[96:111]
    s_add_u32 s49, s49, 1
    s_cmp_eq_u32 s49, 5
    s_cselect_b32 s47, -114688, s7
    s_cselect_b32 s49, 0, s49
    v_add_u32 v8, s47, v8
    v_add_u32 v9, s47, v9
    v_add_u32 v10, s47, v10
    v_add_u32 v11, s47, v11
    v_add_u32 v12, s47, v12
    s_add_u32 s40, s40, 1
    s_cmp_lt_u32 s40, 9
    s_waitcnt lgkmcnt(0)
    v_mfma_f32_32x32x16_bf16 v[64:79], v[36:39], v[32:35], v[64:79]
    s_barrier
    ds_read_b128 v[16:19], v8
    ds_read_b64_tr_b16 v[20:21], v12 offset:0
    ds_read_b64_tr_b16 v[22:23], v12 offset:256
    ds_read_b64_tr_b16 v[24:25], v12 offset:4096
    ds_read_b64_tr_b16 v[26:27], v12 offset:4352
    ds_read_b64_tr_b16 v[28:29], v12 offset:8192
    ds_read_b64_tr_b16 v[30:31], v12 offset:8448
    v_mfma_f32_32x32x16_bf16 v[80:95], v[40:43], v[32:35], v[80:95]
    v_mfma_f32_32x32x16_bf16 v[96:111], v[44:47], v[32:35], v[96:111]
    s_cbranch_scc1 og_loop
    s_waitcnt vmcnt(0) lgkmcnt(0)
    s_nop 15
    s_nop 3
    v_and_b32 v13, 31, v1
    v_lshrrev_b32 v14, 5, v1
    v_mul_u32_u24 v15, 80, v13
    v_lshlrev_b32 v16, 3, v14
    v_add_u32 v15, v15, v16
    s_mul_i32 s40, s32, 7680
    v_add_u32 v15, s40, v15
    v_lshrrev_b32 v16, 2, v1
    v_mul_u32_u24 v17, 80, v16
    v_and_b32 v18, 3, v1
    v_lshlrev_b32 v18, 4, v18
    v_add_u32 v17, v17, v18
    v_add_u32 v17, s40, v17
    s_lshl_b32 s41, s32, 5
    s_add_u32 s41, s41, s36
    v_add_u32 v16, s41, v16
    v_mul_lo_u32 v16, v16, s34
    v_add_u32 v16, v16, v18
    v_add_u32 v16, s38, v16
    s_lshl_b32 s42, s34, 4
    v_cvt_pk_bf16_f32 v20, v64, v65
    v_cvt_pk_bf16_f32 v21, v66, v67
    v_cvt_pk_bf16_f32 v22, v68, v69
    v_cvt_pk_bf16_f32 v23, v70, v71
    v_cvt_pk_bf16_f32 v24, v72, v73
    v_cvt_pk_bf16_f32 v25, v74, v75
    v_cvt_pk_bf16_f32 v26, v76, v77
    v_cvt_pk_bf16_f32 v27, v78, v79
    ds_write_b64 v15, v[20:21] offset:0
    ds_write_b64 v15, v[22:23] offset:16
    ds_write_b64 v15, v[24:25] offset:32
    ds_write_b64 v15, v[26:27] offset:48
    v_cvt_pk_bf16_f32 v20, v80, v81
    v_cvt_pk_bf16_f32 v21, v82, v83
    v_cvt_pk_bf16_f32 v22, v84, v85
    v_cvt_pk_bf16_f32 v23, v86, v87
    v_cvt_pk_bf16_f32 v24, v88, v89
    v_cvt_pk_bf16_f32 v25, v90, v91
    v_cvt_pk_bf16_f32 v26, v92, v93
    v_cvt_pk_bf16_f32 v27, v94, v95
    ds_write_b64 v15, v[20:21] offset:2560
    ds_write_b64 v15, v[22:23] offset:2576
    ds_write_b64 v15, v[24:25] offset:2592
    ds_write_b64 v15, v[26:27] offset:2608
    v_cvt_pk_bf16_f32 v20, v96, v97
    v_cvt_pk_bf16_f32 v21, v98, v99
    v_cvt_pk_bf16_f32 v22, v100, v101
    v_cvt_pk_bf16_f32 v23, v102, v103
    v_cvt_pk_bf16_f32 v24, v104, v105
    v_cvt_pk_bf16_f32 v25, v106, v107
    v_cvt_pk_bf16_f32 v26, v108, v109
    v_cvt_pk_bf16_f32 v27, v110, v111
    ds_write_b64 v15, v[20:21] offset:5120
    ds_write_b64 v15, v[22:23] offset:5136
    ds_write_b64 v15, v[24:25] offset:5152
    ds_write_b64 v15, v[26:27] offset:5168
    s_waitcnt lgkmcnt(0)
    ds_read_b128 v[20:23], v17 offset:0
    ds_read_b128 v[24:27], v17 offset:1280
    ds_read_b128 v[28:31], v17 offset:2560
    ds_read_b128 v[32:35], v17 offset:3840
    ds_read_b128 v[36:39], v17 offset:5120
    ds_read_b128 v[40:43], v17 offset:6400
    s_waitcnt lgkmcnt(4)
    buffer_store_dwordx4 v[20:23], v16, s[16:19], 0 offen offset:0
    buffer_store_dwordx4 v[24:27], v16, s[16:19], s42 offen offset:0
    s_waitcnt lgkmcnt(2)
    buffer_store_dwordx4 v[28:31], v16, s[16:19], 0 offen offset:64
    buffer_store_dwordx4 v[32:35], v16, s[16:19], s42 offen offset:64
    s_cmp_lt_u32 s39, 3
    s_cbranch_scc1 og_skiplast
    s_waitcnt lgkmcnt(0)
    buffer_store_dwordx4 v[36:39], v16, s[16:19], 0 offen offset:128
    buffer_store_dwordx4 v[40:43], v16, s[16:19], s42 offen offset:128
og_skiplast:
    s_branch p3_done
p3_done:
attn_exit:
    s_endpgm
code_end:
.section .rodata,"a"
.p2align 6
kd_start:
.amdhsa_kernel main_kernel
  .amdhsa_next_free_vgpr 168
  .amdhsa_next_free_sgpr 64
  .amdhsa_accum_offset 168
  .amdhsa_group_segment_fixed_size 0
  .amdhsa_kernarg_size 88
  .amdhsa_user_sgpr_count 2
  .amdhsa_user_sgpr_kernarg_segment_ptr 1
  .amdhsa_system_sgpr_workgroup_id_x 1
.end_amdhsa_kernel
```
